```python
import torch

def _softmax(x, axis=-1):
    return torch.softmax(x, dim=axis)

def _gelu(x):
    return torch.nn.functional.gelu(x, approximate='tanh')

def _silu(x):
    return torch.nn.functional.silu(x)

def _sigmoid(x):
    return torch.sigmoid(x)

def _layernorm(x, axis=-1, eps=1e-05):
    m = x.mean(dim=axis, keepdim=True)
    v = x.var(dim=axis, keepdim=True, unbiased=False)
    return (x - m) / torch.sqrt(v + eps)

def _scatter_add(tgt, idx, src, axis=0):
    return tgt.clone().index_add_(axis, idx, src)

def _segment_sum(src, seg, n):
    out = torch.zeros((n,) + src.shape[1:], dtype=src.dtype)
    return out.index_add_(0, seg, src)

def _pad(x, pw):
    flat = tuple((v for pair in reversed(pw) for v in pair))
    return torch.nn.functional.pad(x, flat)
kernel_name = 'adaLN_cond__gqa_block_cached__dense_activation_silu__decode'

def setup_inputs():

    _w = lambda a: (lambda t: t.to(torch.bfloat16) if t.is_floating_point() else t)(torch.as_tensor(a))

    def _A_setup():
        B, Sq, D = (2, 1, 512)
        Hq, Hkv, Sk, Dh = (32, 32, 4096, 128)
        assert Hq % Hkv == 0, (Hq, Hkv)
        return {'x': _w((lambda *s: torch.randn(*s, dtype=torch.bfloat16) * 0.1)(B, Sq, D)), 'k_cache': _w((lambda *s: torch.randn(*s, dtype=torch.bfloat16) * 0.8)(B, Hkv, Sk, Dh)), 'v_cache': _w((lambda *s: torch.randn(*s, dtype=torch.bfloat16) * 3.2)(B, Hkv, Sk, Dh)), 'wq': _w((lambda *s: torch.randn(*s, dtype=torch.bfloat16) * 0.8)(D, Hq * Dh) * D ** (-0.5)), 'wo': _w((lambda *s: torch.randn(*s, dtype=torch.bfloat16) * 3.2)(Hq * Dh, D) * (Hq * Dh) ** (-0.5))}
    _A_in = _A_setup()

    def _B_setup():
        B, S, D, F = (2, 1, 512, 1376)
        return {'x': _w((lambda *s: torch.randn(*s, dtype=torch.bfloat16) * 0.1)(B, S, D)), 'w1': _w((lambda *s: torch.randn(*s, dtype=torch.bfloat16) * 3.2)(D, F) * D ** (-0.5)), 'w2': _w((lambda *s: torch.randn(*s, dtype=torch.bfloat16) * 3.2)(F, D) * F ** (-0.5))}
    _B_in = _B_setup()
    return {'A_x': _A_in['x'], 'A_k_cache': _A_in['k_cache'], 'A_v_cache': _A_in['v_cache'], 'A_wq': _A_in['wq'], 'A_wo': _A_in['wo'], 'B_x': _B_in['x'], 'B_w1': _B_in['w1'], 'B_w2': _B_in['w2'], 'c': _w((lambda *s: torch.randn(*s, dtype=torch.bfloat16) * 0.2)(2, 512) * 8.0), 'w_mod': _w((lambda *s: torch.randn(*s, dtype=torch.bfloat16) * 0.2)(512, 6 * 512) * 512 ** (-0.5) * 8.0)}

def reference(A_x, A_k_cache, A_v_cache, A_wq, A_wo, B_x, B_w1, B_w2, c, w_mod):

    def _A_ref(x, k_cache, v_cache, wq, wo):
        B, Sq, D = x.shape
        Hq, Dh = (32, 128)
        Hkv = k_cache.shape[1]
        rep = Hq // Hkv
        q = (lambda x, *d: x.permute(*d))((x @ wq).reshape(B, Sq, Hq, Dh), 0, 2, 1, 3)
        k = (lambda x, n, axis: torch.repeat_interleave(x, n, dim=axis))(k_cache, rep, axis=1)
        v = (lambda x, n, axis: torch.repeat_interleave(x, n, dim=axis))(v_cache, rep, axis=1)
        scores = torch.einsum('bhqd,bhkd->bhqk', q, k) * Dh ** (-0.5)
        p = _softmax(scores, axis=-1)
        o = torch.einsum('bhqk,bhkd->bhqd', p, v)
        return (lambda x, *d: x.permute(*d))(o, 0, 2, 1, 3).reshape(B, Sq, Hq * Dh) @ wo

    def _B_ref(x, w1, w2):
        h = torch.einsum('bsd,df->bsf', x, w1)
        h = _silu(h)
        out = torch.einsum('bsf,fd->bsd', h, w2)
        return out
    x = A_x
    mod = (_silu(c) @ w_mod).reshape(c.shape[0], 6, 1, -1)
    sa, ca, ga, sb, cb, gb = (mod[:, 0].clone(), mod[:, 1].clone(), mod[:, 2].clone(), mod[:, 3].clone(), mod[:, 4].clone(), mod[:, 5].clone())
    h = _layernorm(x, axis=-1) * (1 + ca) + sa
    x = x + ga * _A_ref(h, A_k_cache, A_v_cache, A_wq, A_wo)
    h = _layernorm(x, axis=-1) * (1 + cb) + sb
    x = x + gb * _B_ref(h, B_w1, B_w2)
    return x
```

```asm
; @launch grid=(256,1,1) block=(512,1,1) lds=151552
.amdgcn_target "amdgcn-amd-amdhsa--gfx950"
.text
.globl adaLN_cond__gqa_block_cached__dense_activation_silu__decode_kernel
.p2align 8
.type adaLN_cond__gqa_block_cached__dense_activation_silu__decode_kernel,@function
adaLN_cond__gqa_block_cached__dense_activation_silu__decode_kernel:
s_cmp_ge_u32 s2, 0x100
s_cbranch_scc1 L_end
s_load_dwordx16 s[4:19], s[0:1], 0
s_load_dwordx8 s[20:27], s[0:1], 64
s_load_dwordx2 s[28:29], s[0:1], 96
v_lshrrev_b32 v1, 6, v0
v_and_b32 v0, 63, v0
s_and_b32 s48, s2, 7
v_readfirstlane_b32 s3, v1
s_lshr_b32 s49, s2, 3
s_lshr_b32 s65, s49, 4
s_lshl_b32 s65, s65, 3
s_add_u32 s65, s65, s48
s_lshl_b32 s65, s65, 2
s_and_b32 s55, s49, 3
s_add_u32 s65, s65, s55
s_lshl_b32 s65, s65, 2
s_bfe_u32 s55, s49, 0x20002
s_add_u32 s65, s65, s55
s_lshl_b32 s65, s65, 18
s_lshl_b32 s55, s3, 12
v_lshlrev_b32 v46, 4, v0
s_mul_i32 s64, s3, 24576
v_add_u32 v1, s55, v46
s_add_u32 s64, s64, 53248
s_waitcnt lgkmcnt(0)
s_cmp_ge_u32 s3, 4
s_cbranch_scc1 L_aux
s_add_u32 s32, s6, s65
s_addc_u32 s33, s7, 0
s_mov_b32 s34, 0x40000
s_mov_b32 s35, 0x20000
s_mov_b32 s56, 163840
s_add_u32 m0, s64, 0
s_nop 0
buffer_load_dwordx4 v1, s[32:35], s56 offen nt lds
s_mov_b32 s56, 164864
s_add_u32 m0, s64, 1024
s_nop 0
buffer_load_dwordx4 v1, s[32:35], s56 offen nt lds
s_mov_b32 s56, 165888
s_add_u32 m0, s64, 2048
s_nop 0
buffer_load_dwordx4 v1, s[32:35], s56 offen nt lds
s_mov_b32 s56, 166912
s_add_u32 m0, s64, 3072
s_nop 0
buffer_load_dwordx4 v1, s[32:35], s56 offen nt lds
s_mov_b32 s56, 180224
s_add_u32 m0, s64, 4096
s_nop 0
buffer_load_dwordx4 v1, s[32:35], s56 offen nt lds
s_mov_b32 s56, 181248
s_add_u32 m0, s64, 5120
s_nop 0
buffer_load_dwordx4 v1, s[32:35], s56 offen nt lds
s_mov_b32 s56, 182272
s_add_u32 m0, s64, 6144
s_nop 0
buffer_load_dwordx4 v1, s[32:35], s56 offen nt lds
s_and_b32 s54, s49, 3
s_lshl_b32 s50, s48, 2
s_add_u32 s50, s50, s54
s_lshr_b32 s51, s49, 2
s_lshr_b32 s52, s51, 2
s_and_b32 s53, s51, 3
v_add_u32 v46, s64, v46
s_lshr_b32 s68, s49, 2
s_and_b32 s69, s49, 3
s_lshl_b32 s69, s69, 2
s_add_u32 s69, s69, s3
s_mul_i32 s69, s69, 196608
s_lshl_b32 s68, s68, 10
s_add_u32 s69, s69, s68
s_lshl_b32 s68, s48, 7
s_add_u32 s69, s69, s68
s_cmp_ge_u32 s49, 24
s_cselect_b32 s69, 0, s69
v_lshrrev_b32 v3, 3, v0
v_mul_u32_u24 v3, 0x1800, v3
v_and_b32 v4, 7, v0
v_lshlrev_b32 v4, 4, v4
v_add_u32 v3, v3, v4
s_lshl_b32 s71, s3, 12
s_add_u32 s71, s71, 20480
s_add_u32 s76, s22, s69
s_addc_u32 s77, s23, 0
s_sub_u32 s78, 3145728, s69
s_mov_b32 s79, 0x20000
s_cmp_ge_u32 s49, 8
s_cbranch_scc1 L_nourg_1
s_mov_b32 s68, 0
s_add_u32 m0, s71, 0
s_nop 0
buffer_load_dwordx4 v3, s[76:79], s68 offen nt lds
s_mov_b32 s68, 49152
s_add_u32 m0, s71, 1024
s_nop 0
buffer_load_dwordx4 v3, s[76:79], s68 offen nt lds
s_mov_b32 s68, 98304
s_add_u32 m0, s71, 2048
s_nop 0
buffer_load_dwordx4 v3, s[76:79], s68 offen nt lds
s_mov_b32 s68, 147456
s_add_u32 m0, s71, 3072
s_nop 0
buffer_load_dwordx4 v3, s[76:79], s68 offen nt lds
L_nourg_1:
s_add_u32 s36, s8, s65
s_addc_u32 s37, s9, 0
s_mov_b32 s38, 0x40000
s_mov_b32 s39, 0x20000
s_lshl_b32 s66, s51, 19
s_lshl_b32 s67, s50, 8
s_add_u32 s66, s66, s67
s_lshl_b32 s67, s3, 17
s_add_u32 s66, s66, s67
s_add_u32 s72, s10, s66
s_addc_u32 s73, s11, 0
s_sub_u32 s74, 4194304, s66
s_mov_b32 s75, 0x20000
v_lshrrev_b32 v2, 4, v0
v_lshlrev_b32 v2, 13, v2
v_and_b32 v4, 15, v0
v_lshlrev_b32 v4, 4, v4
v_add_u32 v2, v2, v4
s_lshl_b32 s67, s3, 12
s_add_u32 s67, s67, 36864
s_barrier
s_waitcnt vmcnt(6)
s_mov_b32 s56, 183296
s_add_u32 m0, s64, 7168
s_nop 0
buffer_load_dwordx4 v1, s[32:35], s56 offen nt lds
s_waitcnt vmcnt(6)
s_mov_b32 s56, 196608
s_add_u32 m0, s64, 8192
s_nop 0
buffer_load_dwordx4 v1, s[32:35], s56 offen nt lds
s_waitcnt vmcnt(6)
s_mov_b32 s56, 197632
s_add_u32 m0, s64, 9216
s_nop 0
buffer_load_dwordx4 v1, s[32:35], s56 offen nt lds
s_waitcnt vmcnt(6)
s_mov_b32 s56, 198656
s_add_u32 m0, s64, 10240
s_nop 0
buffer_load_dwordx4 v1, s[32:35], s56 offen nt lds
s_waitcnt vmcnt(6)
s_mov_b32 s56, 199680
s_add_u32 m0, s64, 11264
s_nop 0
buffer_load_dwordx4 v1, s[32:35], s56 offen nt lds
s_waitcnt vmcnt(6)
s_mov_b32 s56, 212992
s_add_u32 m0, s64, 12288
s_nop 0
buffer_load_dwordx4 v1, s[32:35], s56 offen nt lds
s_waitcnt vmcnt(6)
s_mov_b32 s56, 214016
s_add_u32 m0, s64, 13312
s_nop 0
buffer_load_dwordx4 v1, s[32:35], s56 offen nt lds
s_cmp_ge_u32 s49, 8
s_cbranch_scc1 L_sigm_2
s_mov_b64 exec, 1
v_mov_b32 v4, 0
v_mov_b32 v5, 1
ds_add_u32 v4, v5 offset:388
s_mov_b64 exec, -1
L_sigm_2:
s_waitcnt vmcnt(6)
s_mov_b32 s56, 215040
s_add_u32 m0, s64, 14336
s_nop 0
buffer_load_dwordx4 v1, s[32:35], s56 offen nt lds
s_mov_b32 s68, 0
s_add_u32 m0, s67, 0
s_nop 0
buffer_load_dwordx4 v2, s[72:75], s68 offen nt lds
s_mov_b32 s68, 32768
s_add_u32 m0, s67, 1024
s_nop 0
buffer_load_dwordx4 v2, s[72:75], s68 offen nt lds
s_mov_b32 s68, 65536
s_add_u32 m0, s67, 2048
s_nop 0
buffer_load_dwordx4 v2, s[72:75], s68 offen nt lds
s_mov_b32 s68, 98304
s_add_u32 m0, s67, 3072
s_nop 0
buffer_load_dwordx4 v2, s[72:75], s68 offen nt lds
s_waitcnt vmcnt(6)
s_mov_b32 s56, 216064
s_add_u32 m0, s64, 15360
s_nop 0
buffer_load_dwordx4 v1, s[32:35], s56 offen nt lds
s_waitcnt vmcnt(6)
s_mov_b32 s56, 229376
s_add_u32 m0, s64, 16384
s_nop 0
buffer_load_dwordx4 v1, s[32:35], s56 offen nt lds
s_waitcnt vmcnt(6)
s_mov_b32 s56, 230400
s_add_u32 m0, s64, 17408
s_nop 0
buffer_load_dwordx4 v1, s[32:35], s56 offen nt lds
s_waitcnt vmcnt(6)
s_mov_b32 s56, 231424
s_add_u32 m0, s64, 18432
s_nop 0
buffer_load_dwordx4 v1, s[32:35], s56 offen nt lds
s_waitcnt vmcnt(6)
s_mov_b32 s56, 232448
s_add_u32 m0, s64, 19456
s_nop 0
buffer_load_dwordx4 v1, s[32:35], s56 offen nt lds
s_waitcnt vmcnt(6)
s_mov_b32 s56, 245760
s_add_u32 m0, s64, 20480
s_nop 0
buffer_load_dwordx4 v1, s[32:35], s56 offen nt lds
s_waitcnt vmcnt(6)
s_mov_b32 s56, 246784
s_add_u32 m0, s64, 21504
s_nop 0
buffer_load_dwordx4 v1, s[32:35], s56 offen nt lds
s_mov_b64 exec, 1
v_mov_b32 v4, 0
v_mov_b32 v5, 1
ds_add_u32 v4, v5 offset:392
s_mov_b64 exec, -1
s_waitcnt vmcnt(6)
s_mov_b32 s56, 247808
s_add_u32 m0, s64, 22528
s_nop 0
buffer_load_dwordx4 v1, s[32:35], s56 offen nt lds
s_waitcnt vmcnt(6)
s_mov_b32 s56, 248832
s_add_u32 m0, s64, 23552
s_nop 0
buffer_load_dwordx4 v1, s[32:35], s56 offen nt lds
s_waitcnt vmcnt(6)
s_mov_b32 s56, 0
buffer_load_dwordx4 v[48:51], v1, s[32:35], s56 offen offset:0 nt
s_waitcnt vmcnt(6)
buffer_load_dwordx4 v[52:55], v1, s[32:35], s56 offen offset:1024 nt
s_waitcnt vmcnt(6)
buffer_load_dwordx4 v[56:59], v1, s[32:35], s56 offen offset:2048 nt
s_waitcnt vmcnt(6)
buffer_load_dwordx4 v[60:63], v1, s[32:35], s56 offen offset:3072 nt
s_waitcnt vmcnt(6)
s_mov_b32 s56, 16384
buffer_load_dwordx4 v[64:67], v1, s[32:35], s56 offen offset:0 nt
s_waitcnt vmcnt(6)
buffer_load_dwordx4 v[68:71], v1, s[32:35], s56 offen offset:1024 nt
s_waitcnt vmcnt(6)
buffer_load_dwordx4 v[72:75], v1, s[32:35], s56 offen offset:2048 nt
s_waitcnt vmcnt(6)
buffer_load_dwordx4 v[76:79], v1, s[32:35], s56 offen offset:3072 nt
s_waitcnt vmcnt(6)
s_mov_b32 s56, 32768
buffer_load_dwordx4 v[80:83], v1, s[32:35], s56 offen offset:0 nt
s_waitcnt vmcnt(6)
buffer_load_dwordx4 v[84:87], v1, s[32:35], s56 offen offset:1024 nt
s_waitcnt vmcnt(6)
buffer_load_dwordx4 v[88:91], v1, s[32:35], s56 offen offset:2048 nt
s_waitcnt vmcnt(6)
buffer_load_dwordx4 v[92:95], v1, s[32:35], s56 offen offset:3072 nt
s_waitcnt vmcnt(6)
s_mov_b32 s56, 49152
buffer_load_dwordx4 v[96:99], v1, s[32:35], s56 offen offset:0 nt
s_waitcnt vmcnt(6)
buffer_load_dwordx4 v[100:103], v1, s[32:35], s56 offen offset:1024 nt
s_waitcnt vmcnt(6)
buffer_load_dwordx4 v[104:107], v1, s[32:35], s56 offen offset:2048 nt
s_waitcnt vmcnt(6)
buffer_load_dwordx4 v[108:111], v1, s[32:35], s56 offen offset:3072 nt
s_waitcnt vmcnt(6)
s_mov_b32 s56, 65536
buffer_load_dwordx4 v[112:115], v1, s[32:35], s56 offen offset:0 nt
s_cmp_lt_u32 s49, 8
s_cbranch_scc1 L_late_3
s_cmp_ge_u32 s49, 24
s_cbranch_scc1 L_late_3
s_mov_b32 s68, 0
s_add_u32 m0, s71, 0
s_nop 0
buffer_load_dwordx4 v3, s[76:79], s68 offen nt lds
s_mov_b32 s68, 49152
s_add_u32 m0, s71, 1024
s_nop 0
buffer_load_dwordx4 v3, s[76:79], s68 offen nt lds
s_mov_b32 s68, 98304
s_add_u32 m0, s71, 2048
s_nop 0
buffer_load_dwordx4 v3, s[76:79], s68 offen nt lds
s_mov_b32 s68, 147456
s_add_u32 m0, s71, 3072
s_nop 0
buffer_load_dwordx4 v3, s[76:79], s68 offen nt lds
L_late_3:
s_waitcnt vmcnt(6)
buffer_load_dwordx4 v[116:119], v1, s[32:35], s56 offen offset:1024 nt
s_waitcnt vmcnt(6)
buffer_load_dwordx4 v[120:123], v1, s[32:35], s56 offen offset:2048 nt
s_waitcnt vmcnt(6)
buffer_load_dwordx4 v[124:127], v1, s[32:35], s56 offen offset:3072 nt
s_waitcnt vmcnt(6)
s_mov_b32 s56, 81920
buffer_load_dwordx4 v[128:131], v1, s[32:35], s56 offen offset:0 nt
s_waitcnt vmcnt(6)
buffer_load_dwordx4 v[132:135], v1, s[32:35], s56 offen offset:1024 nt
s_waitcnt vmcnt(6)
buffer_load_dwordx4 v[136:139], v1, s[32:35], s56 offen offset:2048 nt
s_waitcnt vmcnt(6)
buffer_load_dwordx4 v[140:143], v1, s[32:35], s56 offen offset:3072 nt
s_cmp_lt_u32 s49, 8
s_cbranch_scc1 L_sigl_4
s_mov_b64 exec, 1
v_mov_b32 v4, 0
v_mov_b32 v5, 1
ds_add_u32 v4, v5 offset:388
s_mov_b64 exec, -1
L_sigl_4:
s_waitcnt vmcnt(6)
s_mov_b32 s56, 98304
buffer_load_dwordx4 v[144:147], v1, s[32:35], s56 offen offset:0 nt
s_mov_b64 exec, 1
v_mov_b32 v4, 0
v_mov_b32 v5, 1
ds_add_u32 v4, v5 offset:416
s_mov_b64 exec, -1
s_waitcnt vmcnt(6)
buffer_load_dwordx4 v[148:151], v1, s[32:35], s56 offen offset:1024 nt
s_waitcnt vmcnt(6)
buffer_load_dwordx4 v[152:155], v1, s[32:35], s56 offen offset:2048 nt
s_waitcnt vmcnt(6)
buffer_load_dwordx4 v[156:159], v1, s[32:35], s56 offen offset:3072 nt
s_waitcnt vmcnt(6)
s_mov_b32 s56, 114688
buffer_load_dwordx4 v[160:163], v1, s[32:35], s56 offen offset:0 nt
s_waitcnt vmcnt(6)
buffer_load_dwordx4 v[164:167], v1, s[32:35], s56 offen offset:1024 nt
s_waitcnt vmcnt(6)
buffer_load_dwordx4 v[168:171], v1, s[32:35], s56 offen offset:2048 nt
s_waitcnt vmcnt(6)
buffer_load_dwordx4 v[172:175], v1, s[32:35], s56 offen offset:3072 nt
s_waitcnt vmcnt(6)
s_mov_b32 s56, 131072
buffer_load_dwordx4 v[176:179], v1, s[32:35], s56 offen offset:0 nt
s_waitcnt vmcnt(6)
buffer_load_dwordx4 v[180:183], v1, s[32:35], s56 offen offset:1024 nt
s_waitcnt vmcnt(6)
buffer_load_dwordx4 v[184:187], v1, s[32:35], s56 offen offset:2048 nt
s_waitcnt vmcnt(6)
buffer_load_dwordx4 v[188:191], v1, s[32:35], s56 offen offset:3072 nt
s_waitcnt vmcnt(6)
s_mov_b32 s56, 147456
buffer_load_dwordx4 v[192:195], v1, s[32:35], s56 offen offset:0 nt
s_waitcnt vmcnt(6)
buffer_load_dwordx4 v[196:199], v1, s[32:35], s56 offen offset:1024 nt
s_waitcnt vmcnt(6)
buffer_load_dwordx4 v[200:203], v1, s[32:35], s56 offen offset:2048 nt
s_waitcnt vmcnt(6)
buffer_load_dwordx4 v[204:207], v1, s[32:35], s56 offen offset:3072 nt
s_waitcnt vmcnt(6)
s_mov_b32 s57, 0
buffer_load_dwordx4 v[208:211], v1, s[36:39], s57 offen offset:0 nt
s_waitcnt vmcnt(6)
buffer_load_dwordx4 v[212:215], v1, s[36:39], s57 offen offset:1024 nt
s_waitcnt vmcnt(6)
buffer_load_dwordx4 v[216:219], v1, s[36:39], s57 offen offset:2048 nt
s_waitcnt vmcnt(6)
buffer_load_dwordx4 v[220:223], v1, s[36:39], s57 offen offset:3072 nt
s_waitcnt vmcnt(6)
s_mov_b32 s57, 16384
buffer_load_dwordx4 v[224:227], v1, s[36:39], s57 offen offset:0 nt
s_waitcnt vmcnt(6)
buffer_load_dwordx4 v[228:231], v1, s[36:39], s57 offen offset:1024 nt
s_waitcnt vmcnt(6)
buffer_load_dwordx4 v[232:235], v1, s[36:39], s57 offen offset:2048 nt
s_waitcnt vmcnt(6)
buffer_load_dwordx4 v[236:239], v1, s[36:39], s57 offen offset:3072 nt
v_and_b32 v42, 15, v0
v_lshrrev_b32 v43, 1, v42
v_and_b32 v44, 1, v42
v_mov_b32 v45, 0xffff
v_mov_b32 v26, 0xffff0000
v_cmp_eq_u32 vcc, 1, v44
s_nop 1
v_cndmask_b32 v45, v45, v26, vcc
v_cmp_eq_u32 vcc, 0, v43
s_nop 1
v_cndmask_b32 v6, 0, v45, vcc
v_cmp_eq_u32 vcc, 1, v43
s_nop 1
v_cndmask_b32 v7, 0, v45, vcc
v_cmp_eq_u32 vcc, 2, v43
s_nop 1
v_cndmask_b32 v8, 0, v45, vcc
v_cmp_eq_u32 vcc, 3, v43
s_nop 1
v_cndmask_b32 v9, 0, v45, vcc
s_mov_b32 s60, 0xcccccccc
s_mov_b32 s61, 0xcccccccc
s_mov_b32 s62, 0xaaaaaaaa
s_mov_b32 s63, 0xaaaaaaaa
v_mov_b32 v10, 0
v_mov_b32 v11, 0
v_mov_b32 v12, 0
v_mov_b32 v13, 0
v_lshlrev_b32 v42, 4, v42
s_barrier
ds_read_b128 v[2:5], v42 offset:0
s_waitcnt lgkmcnt(0)
s_waitcnt vmcnt(44)
v_dot2_f32_bf16 v26, v48, v2, 0
v_dot2_f32_bf16 v27, v52, v2, 0
v_dot2_f32_bf16 v28, v56, v2, 0
v_dot2_f32_bf16 v29, v60, v2, 0
v_dot2_f32_bf16 v26, v49, v3, v26
v_dot2_f32_bf16 v27, v53, v3, v27
v_dot2_f32_bf16 v28, v57, v3, v28
v_dot2_f32_bf16 v29, v61, v3, v29
v_dot2_f32_bf16 v26, v50, v4, v26
v_dot2_f32_bf16 v27, v54, v4, v27
v_dot2_f32_bf16 v28, v58, v4, v28
v_dot2_f32_bf16 v29, v62, v4, v29
v_dot2_f32_bf16 v26, v51, v5, v26
v_dot2_f32_bf16 v27, v55, v5, v27
v_dot2_f32_bf16 v28, v59, v5, v28
v_dot2_f32_bf16 v29, v63, v5, v29
s_waitcnt vmcnt(40)
v_dot2_f32_bf16 v30, v64, v2, 0
v_dot2_f32_bf16 v31, v68, v2, 0
v_dot2_f32_bf16 v32, v72, v2, 0
v_dot2_f32_bf16 v33, v76, v2, 0
v_dot2_f32_bf16 v30, v65, v3, v30
v_dot2_f32_bf16 v31, v69, v3, v31
v_dot2_f32_bf16 v32, v73, v3, v32
v_dot2_f32_bf16 v33, v77, v3, v33
v_dot2_f32_bf16 v30, v66, v4, v30
v_dot2_f32_bf16 v31, v70, v4, v31
v_dot2_f32_bf16 v32, v74, v4, v32
v_dot2_f32_bf16 v33, v78, v4, v33
v_dot2_f32_bf16 v30, v67, v5, v30
v_dot2_f32_bf16 v31, v71, v5, v31
v_dot2_f32_bf16 v32, v75, v5, v32
v_dot2_f32_bf16 v33, v79, v5, v33
s_waitcnt vmcnt(5)
s_mov_b32 s57, 32768
buffer_load_dwordx4 v[48:51], v1, s[36:39], s57 offen offset:0 nt
s_waitcnt vmcnt(37)
v_dot2_f32_bf16 v34, v80, v2, 0
v_dot2_f32_bf16 v35, v84, v2, 0
v_dot2_f32_bf16 v36, v88, v2, 0
v_dot2_f32_bf16 v37, v92, v2, 0
v_dot2_f32_bf16 v34, v81, v3, v34
v_dot2_f32_bf16 v35, v85, v3, v35
v_dot2_f32_bf16 v36, v89, v3, v36
v_dot2_f32_bf16 v37, v93, v3, v37
v_dot2_f32_bf16 v34, v82, v4, v34
v_dot2_f32_bf16 v35, v86, v4, v35
v_dot2_f32_bf16 v36, v90, v4, v36
v_dot2_f32_bf16 v37, v94, v4, v37
v_dot2_f32_bf16 v34, v83, v5, v34
v_dot2_f32_bf16 v35, v87, v5, v35
v_dot2_f32_bf16 v36, v91, v5, v36
v_dot2_f32_bf16 v37, v95, v5, v37
s_waitcnt vmcnt(33)
v_dot2_f32_bf16 v38, v96, v2, 0
v_dot2_f32_bf16 v39, v100, v2, 0
v_dot2_f32_bf16 v40, v104, v2, 0
v_dot2_f32_bf16 v41, v108, v2, 0
v_dot2_f32_bf16 v38, v97, v3, v38
v_dot2_f32_bf16 v39, v101, v3, v39
v_dot2_f32_bf16 v40, v105, v3, v40
v_dot2_f32_bf16 v41, v109, v3, v41
v_dot2_f32_bf16 v38, v98, v4, v38
v_dot2_f32_bf16 v39, v102, v4, v39
v_dot2_f32_bf16 v40, v106, v4, v40
v_dot2_f32_bf16 v41, v110, v4, v41
v_dot2_f32_bf16 v38, v99, v5, v38
v_dot2_f32_bf16 v39, v103, v5, v39
v_dot2_f32_bf16 v40, v107, v5, v40
v_dot2_f32_bf16 v41, v111, v5, v41
s_waitcnt vmcnt(5)
buffer_load_dwordx4 v[52:55], v1, s[36:39], s57 offen offset:1024 nt
s_nop 2
v_add_f32_dpp v26, v26, v26 row_ror:8 row_mask:0xf bank_mask:0x3
v_add_f32_dpp v26, v34, v34 row_ror:8 row_mask:0xf bank_mask:0xc
v_add_f32_dpp v27, v27, v27 row_ror:8 row_mask:0xf bank_mask:0x3
v_add_f32_dpp v27, v35, v35 row_ror:8 row_mask:0xf bank_mask:0xc
v_add_f32_dpp v28, v28, v28 row_ror:8 row_mask:0xf bank_mask:0x3
v_add_f32_dpp v28, v36, v36 row_ror:8 row_mask:0xf bank_mask:0xc
v_add_f32_dpp v29, v29, v29 row_ror:8 row_mask:0xf bank_mask:0x3
v_add_f32_dpp v29, v37, v37 row_ror:8 row_mask:0xf bank_mask:0xc
v_add_f32_dpp v30, v30, v30 row_ror:8 row_mask:0xf bank_mask:0x3
v_add_f32_dpp v30, v38, v38 row_ror:8 row_mask:0xf bank_mask:0xc
v_add_f32_dpp v31, v31, v31 row_ror:8 row_mask:0xf bank_mask:0x3
v_add_f32_dpp v31, v39, v39 row_ror:8 row_mask:0xf bank_mask:0xc
v_add_f32_dpp v32, v32, v32 row_ror:8 row_mask:0xf bank_mask:0x3
v_add_f32_dpp v32, v40, v40 row_ror:8 row_mask:0xf bank_mask:0xc
v_add_f32_dpp v33, v33, v33 row_ror:8 row_mask:0xf bank_mask:0x3
v_add_f32_dpp v33, v41, v41 row_ror:8 row_mask:0xf bank_mask:0xc
v_add_f32_dpp v26, v26, v26 row_shl:4 row_mask:0xf bank_mask:0x5
v_add_f32_dpp v26, v30, v30 row_shr:4 row_mask:0xf bank_mask:0xa
v_add_f32_dpp v27, v27, v27 row_shl:4 row_mask:0xf bank_mask:0x5
v_add_f32_dpp v27, v31, v31 row_shr:4 row_mask:0xf bank_mask:0xa
v_add_f32_dpp v28, v28, v28 row_shl:4 row_mask:0xf bank_mask:0x5
v_add_f32_dpp v28, v32, v32 row_shr:4 row_mask:0xf bank_mask:0xa
v_add_f32_dpp v29, v29, v29 row_shl:4 row_mask:0xf bank_mask:0x5
v_add_f32_dpp v29, v33, v33 row_shr:4 row_mask:0xf bank_mask:0xa
s_nop 0
v_add_f32_dpp v26, v26, v26 quad_perm:[2,3,0,1] row_mask:0xf bank_mask:0xf
v_add_f32_dpp v27, v27, v27 quad_perm:[2,3,0,1] row_mask:0xf bank_mask:0xf
v_add_f32_dpp v28, v28, v28 quad_perm:[2,3,0,1] row_mask:0xf bank_mask:0xf
v_add_f32_dpp v29, v29, v29 quad_perm:[2,3,0,1] row_mask:0xf bank_mask:0xf
v_cndmask_b32 v26, v26, v28, s[60:61]
v_cndmask_b32 v27, v27, v29, s[60:61]
s_nop 1
v_add_f32_dpp v26, v26, v26 quad_perm:[1,0,3,2] row_mask:0xf bank_mask:0xf
v_add_f32_dpp v27, v27, v27 quad_perm:[1,0,3,2] row_mask:0xf bank_mask:0xf
v_cndmask_b32 v22, v26, v27, s[62:63]
s_waitcnt vmcnt(30)
v_dot2_f32_bf16 v26, v112, v2, 0
v_dot2_f32_bf16 v27, v116, v2, 0
v_dot2_f32_bf16 v28, v120, v2, 0
v_dot2_f32_bf16 v29, v124, v2, 0
v_dot2_f32_bf16 v26, v113, v3, v26
v_dot2_f32_bf16 v27, v117, v3, v27
v_dot2_f32_bf16 v28, v121, v3, v28
v_dot2_f32_bf16 v29, v125, v3, v29
v_dot2_f32_bf16 v26, v114, v4, v26
v_dot2_f32_bf16 v27, v118, v4, v27
v_dot2_f32_bf16 v28, v122, v4, v28
v_dot2_f32_bf16 v29, v126, v4, v29
v_dot2_f32_bf16 v26, v115, v5, v26
v_dot2_f32_bf16 v27, v119, v5, v27
v_dot2_f32_bf16 v28, v123, v5, v28
v_dot2_f32_bf16 v29, v127, v5, v29
s_waitcnt vmcnt(26)
v_dot2_f32_bf16 v30, v128, v2, 0
v_dot2_f32_bf16 v31, v132, v2, 0
v_dot2_f32_bf16 v32, v136, v2, 0
v_dot2_f32_bf16 v33, v140, v2, 0
v_dot2_f32_bf16 v30, v129, v3, v30
v_dot2_f32_bf16 v31, v133, v3, v31
v_dot2_f32_bf16 v32, v137, v3, v32
v_dot2_f32_bf16 v33, v141, v3, v33
v_dot2_f32_bf16 v30, v130, v4, v30
v_dot2_f32_bf16 v31, v134, v4, v31
v_dot2_f32_bf16 v32, v138, v4, v32
v_dot2_f32_bf16 v33, v142, v4, v33
v_dot2_f32_bf16 v30, v131, v5, v30
v_dot2_f32_bf16 v31, v135, v5, v31
v_dot2_f32_bf16 v32, v139, v5, v32
v_dot2_f32_bf16 v33, v143, v5, v33
s_waitcnt vmcnt(5)
buffer_load_dwordx4 v[56:59], v1, s[36:39], s57 offen offset:2048 nt
s_waitcnt vmcnt(23)
v_dot2_f32_bf16 v34, v144, v2, 0
v_dot2_f32_bf16 v35, v148, v2, 0
v_dot2_f32_bf16 v36, v152, v2, 0
v_dot2_f32_bf16 v37, v156, v2, 0
v_dot2_f32_bf16 v34, v145, v3, v34
v_dot2_f32_bf16 v35, v149, v3, v35
v_dot2_f32_bf16 v36, v153, v3, v36
v_dot2_f32_bf16 v37, v157, v3, v37
v_dot2_f32_bf16 v34, v146, v4, v34
v_dot2_f32_bf16 v35, v150, v4, v35
v_dot2_f32_bf16 v36, v154, v4, v36
v_dot2_f32_bf16 v37, v158, v4, v37
v_dot2_f32_bf16 v34, v147, v5, v34
v_dot2_f32_bf16 v35, v151, v5, v35
v_dot2_f32_bf16 v36, v155, v5, v36
v_dot2_f32_bf16 v37, v159, v5, v37
s_waitcnt vmcnt(19)
v_dot2_f32_bf16 v38, v160, v2, 0
v_dot2_f32_bf16 v39, v164, v2, 0
v_dot2_f32_bf16 v40, v168, v2, 0
v_dot2_f32_bf16 v41, v172, v2, 0
v_dot2_f32_bf16 v38, v161, v3, v38
v_dot2_f32_bf16 v39, v165, v3, v39
v_dot2_f32_bf16 v40, v169, v3, v40
v_dot2_f32_bf16 v41, v173, v3, v41
v_dot2_f32_bf16 v38, v162, v4, v38
v_dot2_f32_bf16 v39, v166, v4, v39
v_dot2_f32_bf16 v40, v170, v4, v40
v_dot2_f32_bf16 v41, v174, v4, v41
v_dot2_f32_bf16 v38, v163, v5, v38
v_dot2_f32_bf16 v39, v167, v5, v39
v_dot2_f32_bf16 v40, v171, v5, v40
v_dot2_f32_bf16 v41, v175, v5, v41
s_waitcnt vmcnt(5)
buffer_load_dwordx4 v[60:63], v1, s[36:39], s57 offen offset:3072 nt
s_nop 2
v_add_f32_dpp v26, v26, v26 row_ror:8 row_mask:0xf bank_mask:0x3
v_add_f32_dpp v26, v34, v34 row_ror:8 row_mask:0xf bank_mask:0xc
v_add_f32_dpp v27, v27, v27 row_ror:8 row_mask:0xf bank_mask:0x3
v_add_f32_dpp v27, v35, v35 row_ror:8 row_mask:0xf bank_mask:0xc
v_add_f32_dpp v28, v28, v28 row_ror:8 row_mask:0xf bank_mask:0x3
v_add_f32_dpp v28, v36, v36 row_ror:8 row_mask:0xf bank_mask:0xc
v_add_f32_dpp v29, v29, v29 row_ror:8 row_mask:0xf bank_mask:0x3
v_add_f32_dpp v29, v37, v37 row_ror:8 row_mask:0xf bank_mask:0xc
v_add_f32_dpp v30, v30, v30 row_ror:8 row_mask:0xf bank_mask:0x3
v_add_f32_dpp v30, v38, v38 row_ror:8 row_mask:0xf bank_mask:0xc
v_add_f32_dpp v31, v31, v31 row_ror:8 row_mask:0xf bank_mask:0x3
v_add_f32_dpp v31, v39, v39 row_ror:8 row_mask:0xf bank_mask:0xc
v_add_f32_dpp v32, v32, v32 row_ror:8 row_mask:0xf bank_mask:0x3
v_add_f32_dpp v32, v40, v40 row_ror:8 row_mask:0xf bank_mask:0xc
v_add_f32_dpp v33, v33, v33 row_ror:8 row_mask:0xf bank_mask:0x3
v_add_f32_dpp v33, v41, v41 row_ror:8 row_mask:0xf bank_mask:0xc
v_add_f32_dpp v26, v26, v26 row_shl:4 row_mask:0xf bank_mask:0x5
v_add_f32_dpp v26, v30, v30 row_shr:4 row_mask:0xf bank_mask:0xa
v_add_f32_dpp v27, v27, v27 row_shl:4 row_mask:0xf bank_mask:0x5
v_add_f32_dpp v27, v31, v31 row_shr:4 row_mask:0xf bank_mask:0xa
v_add_f32_dpp v28, v28, v28 row_shl:4 row_mask:0xf bank_mask:0x5
v_add_f32_dpp v28, v32, v32 row_shr:4 row_mask:0xf bank_mask:0xa
v_add_f32_dpp v29, v29, v29 row_shl:4 row_mask:0xf bank_mask:0x5
v_add_f32_dpp v29, v33, v33 row_shr:4 row_mask:0xf bank_mask:0xa
s_nop 0
v_add_f32_dpp v26, v26, v26 quad_perm:[2,3,0,1] row_mask:0xf bank_mask:0xf
v_add_f32_dpp v27, v27, v27 quad_perm:[2,3,0,1] row_mask:0xf bank_mask:0xf
v_add_f32_dpp v28, v28, v28 quad_perm:[2,3,0,1] row_mask:0xf bank_mask:0xf
v_add_f32_dpp v29, v29, v29 quad_perm:[2,3,0,1] row_mask:0xf bank_mask:0xf
v_cndmask_b32 v26, v26, v28, s[60:61]
v_cndmask_b32 v27, v27, v29, s[60:61]
s_nop 1
v_add_f32_dpp v26, v26, v26 quad_perm:[1,0,3,2] row_mask:0xf bank_mask:0xf
v_add_f32_dpp v27, v27, v27 quad_perm:[1,0,3,2] row_mask:0xf bank_mask:0xf
v_cndmask_b32 v23, v26, v27, s[62:63]
ds_read_b128 v[144:147], v46 offset:0
ds_read_b128 v[148:151], v46 offset:1024
ds_read_b128 v[152:155], v46 offset:2048
ds_read_b128 v[156:159], v46 offset:3072
ds_read_b128 v[160:163], v46 offset:4096
ds_read_b128 v[164:167], v46 offset:5120
ds_read_b128 v[168:171], v46 offset:6144
ds_read_b128 v[172:175], v46 offset:7168
s_waitcnt vmcnt(16)
v_dot2_f32_bf16 v26, v176, v2, 0
v_dot2_f32_bf16 v27, v180, v2, 0
v_dot2_f32_bf16 v28, v184, v2, 0
v_dot2_f32_bf16 v29, v188, v2, 0
v_dot2_f32_bf16 v26, v177, v3, v26
v_dot2_f32_bf16 v27, v181, v3, v27
v_dot2_f32_bf16 v28, v185, v3, v28
v_dot2_f32_bf16 v29, v189, v3, v29
v_dot2_f32_bf16 v26, v178, v4, v26
v_dot2_f32_bf16 v27, v182, v4, v27
v_dot2_f32_bf16 v28, v186, v4, v28
v_dot2_f32_bf16 v29, v190, v4, v29
v_dot2_f32_bf16 v26, v179, v5, v26
v_dot2_f32_bf16 v27, v183, v5, v27
v_dot2_f32_bf16 v28, v187, v5, v28
v_dot2_f32_bf16 v29, v191, v5, v29
s_waitcnt vmcnt(12)
v_dot2_f32_bf16 v30, v192, v2, 0
v_dot2_f32_bf16 v31, v196, v2, 0
v_dot2_f32_bf16 v32, v200, v2, 0
v_dot2_f32_bf16 v33, v204, v2, 0
v_dot2_f32_bf16 v30, v193, v3, v30
v_dot2_f32_bf16 v31, v197, v3, v31
v_dot2_f32_bf16 v32, v201, v3, v32
v_dot2_f32_bf16 v33, v205, v3, v33
v_dot2_f32_bf16 v30, v194, v4, v30
v_dot2_f32_bf16 v31, v198, v4, v31
v_dot2_f32_bf16 v32, v202, v4, v32
v_dot2_f32_bf16 v33, v206, v4, v33
v_dot2_f32_bf16 v30, v195, v5, v30
v_dot2_f32_bf16 v31, v199, v5, v31
v_dot2_f32_bf16 v32, v203, v5, v32
v_dot2_f32_bf16 v33, v207, v5, v33
s_waitcnt vmcnt(5)
s_mov_b32 s57, 49152
buffer_load_dwordx4 v[64:67], v1, s[36:39], s57 offen offset:0 nt
s_waitcnt lgkmcnt(0)
v_dot2_f32_bf16 v34, v144, v2, 0
v_dot2_f32_bf16 v35, v148, v2, 0
v_dot2_f32_bf16 v36, v152, v2, 0
v_dot2_f32_bf16 v37, v156, v2, 0
v_dot2_f32_bf16 v34, v145, v3, v34
v_dot2_f32_bf16 v35, v149, v3, v35
v_dot2_f32_bf16 v36, v153, v3, v36
v_dot2_f32_bf16 v37, v157, v3, v37
v_dot2_f32_bf16 v34, v146, v4, v34
v_dot2_f32_bf16 v35, v150, v4, v35
v_dot2_f32_bf16 v36, v154, v4, v36
v_dot2_f32_bf16 v37, v158, v4, v37
v_dot2_f32_bf16 v34, v147, v5, v34
v_dot2_f32_bf16 v35, v151, v5, v35
v_dot2_f32_bf16 v36, v155, v5, v36
v_dot2_f32_bf16 v37, v159, v5, v37
s_waitcnt lgkmcnt(0)
v_dot2_f32_bf16 v38, v160, v2, 0
v_dot2_f32_bf16 v39, v164, v2, 0
v_dot2_f32_bf16 v40, v168, v2, 0
v_dot2_f32_bf16 v41, v172, v2, 0
v_dot2_f32_bf16 v38, v161, v3, v38
v_dot2_f32_bf16 v39, v165, v3, v39
v_dot2_f32_bf16 v40, v169, v3, v40
v_dot2_f32_bf16 v41, v173, v3, v41
v_dot2_f32_bf16 v38, v162, v4, v38
v_dot2_f32_bf16 v39, v166, v4, v39
v_dot2_f32_bf16 v40, v170, v4, v40
v_dot2_f32_bf16 v41, v174, v4, v41
v_dot2_f32_bf16 v38, v163, v5, v38
v_dot2_f32_bf16 v39, v167, v5, v39
v_dot2_f32_bf16 v40, v171, v5, v40
v_dot2_f32_bf16 v41, v175, v5, v41
s_waitcnt vmcnt(5)
buffer_load_dwordx4 v[68:71], v1, s[36:39], s57 offen offset:1024 nt
s_nop 2
v_add_f32_dpp v26, v26, v26 row_ror:8 row_mask:0xf bank_mask:0x3
v_add_f32_dpp v26, v34, v34 row_ror:8 row_mask:0xf bank_mask:0xc
v_add_f32_dpp v27, v27, v27 row_ror:8 row_mask:0xf bank_mask:0x3
v_add_f32_dpp v27, v35, v35 row_ror:8 row_mask:0xf bank_mask:0xc
v_add_f32_dpp v28, v28, v28 row_ror:8 row_mask:0xf bank_mask:0x3
v_add_f32_dpp v28, v36, v36 row_ror:8 row_mask:0xf bank_mask:0xc
v_add_f32_dpp v29, v29, v29 row_ror:8 row_mask:0xf bank_mask:0x3
v_add_f32_dpp v29, v37, v37 row_ror:8 row_mask:0xf bank_mask:0xc
v_add_f32_dpp v30, v30, v30 row_ror:8 row_mask:0xf bank_mask:0x3
v_add_f32_dpp v30, v38, v38 row_ror:8 row_mask:0xf bank_mask:0xc
v_add_f32_dpp v31, v31, v31 row_ror:8 row_mask:0xf bank_mask:0x3
v_add_f32_dpp v31, v39, v39 row_ror:8 row_mask:0xf bank_mask:0xc
v_add_f32_dpp v32, v32, v32 row_ror:8 row_mask:0xf bank_mask:0x3
v_add_f32_dpp v32, v40, v40 row_ror:8 row_mask:0xf bank_mask:0xc
v_add_f32_dpp v33, v33, v33 row_ror:8 row_mask:0xf bank_mask:0x3
v_add_f32_dpp v33, v41, v41 row_ror:8 row_mask:0xf bank_mask:0xc
v_add_f32_dpp v26, v26, v26 row_shl:4 row_mask:0xf bank_mask:0x5
v_add_f32_dpp v26, v30, v30 row_shr:4 row_mask:0xf bank_mask:0xa
v_add_f32_dpp v27, v27, v27 row_shl:4 row_mask:0xf bank_mask:0x5
v_add_f32_dpp v27, v31, v31 row_shr:4 row_mask:0xf bank_mask:0xa
v_add_f32_dpp v28, v28, v28 row_shl:4 row_mask:0xf bank_mask:0x5
v_add_f32_dpp v28, v32, v32 row_shr:4 row_mask:0xf bank_mask:0xa
v_add_f32_dpp v29, v29, v29 row_shl:4 row_mask:0xf bank_mask:0x5
v_add_f32_dpp v29, v33, v33 row_shr:4 row_mask:0xf bank_mask:0xa
s_nop 0
v_add_f32_dpp v26, v26, v26 quad_perm:[2,3,0,1] row_mask:0xf bank_mask:0xf
v_add_f32_dpp v27, v27, v27 quad_perm:[2,3,0,1] row_mask:0xf bank_mask:0xf
v_add_f32_dpp v28, v28, v28 quad_perm:[2,3,0,1] row_mask:0xf bank_mask:0xf
v_add_f32_dpp v29, v29, v29 quad_perm:[2,3,0,1] row_mask:0xf bank_mask:0xf
v_cndmask_b32 v26, v26, v28, s[60:61]
v_cndmask_b32 v27, v27, v29, s[60:61]
s_nop 1
v_add_f32_dpp v26, v26, v26 quad_perm:[1,0,3,2] row_mask:0xf bank_mask:0xf
v_add_f32_dpp v27, v27, v27 quad_perm:[1,0,3,2] row_mask:0xf bank_mask:0xf
v_cndmask_b32 v24, v26, v27, s[62:63]
ds_read_b128 v[112:115], v46 offset:8192
ds_read_b128 v[116:119], v46 offset:9216
ds_read_b128 v[120:123], v46 offset:10240
ds_read_b128 v[124:127], v46 offset:11264
ds_read_b128 v[128:131], v46 offset:12288
ds_read_b128 v[132:135], v46 offset:13312
ds_read_b128 v[136:139], v46 offset:14336
ds_read_b128 v[140:143], v46 offset:15360
ds_read_b128 v[144:147], v46 offset:16384
ds_read_b128 v[148:151], v46 offset:17408
ds_read_b128 v[152:155], v46 offset:18432
ds_read_b128 v[156:159], v46 offset:19456
ds_read_b128 v[160:163], v46 offset:20480
ds_read_b128 v[164:167], v46 offset:21504
ds_read_b128 v[168:171], v46 offset:22528
ds_read_b128 v[172:175], v46 offset:23552
s_waitcnt lgkmcnt(0)
v_dot2_f32_bf16 v26, v112, v2, 0
v_dot2_f32_bf16 v27, v116, v2, 0
v_dot2_f32_bf16 v28, v120, v2, 0
v_dot2_f32_bf16 v29, v124, v2, 0
v_dot2_f32_bf16 v26, v113, v3, v26
v_dot2_f32_bf16 v27, v117, v3, v27
v_dot2_f32_bf16 v28, v121, v3, v28
v_dot2_f32_bf16 v29, v125, v3, v29
v_dot2_f32_bf16 v26, v114, v4, v26
v_dot2_f32_bf16 v27, v118, v4, v27
v_dot2_f32_bf16 v28, v122, v4, v28
v_dot2_f32_bf16 v29, v126, v4, v29
v_dot2_f32_bf16 v26, v115, v5, v26
v_dot2_f32_bf16 v27, v119, v5, v27
v_dot2_f32_bf16 v28, v123, v5, v28
v_dot2_f32_bf16 v29, v127, v5, v29
s_waitcnt lgkmcnt(0)
v_dot2_f32_bf16 v30, v128, v2, 0
v_dot2_f32_bf16 v31, v132, v2, 0
v_dot2_f32_bf16 v32, v136, v2, 0
v_dot2_f32_bf16 v33, v140, v2, 0
v_dot2_f32_bf16 v30, v129, v3, v30
v_dot2_f32_bf16 v31, v133, v3, v31
v_dot2_f32_bf16 v32, v137, v3, v32
v_dot2_f32_bf16 v33, v141, v3, v33
v_dot2_f32_bf16 v30, v130, v4, v30
v_dot2_f32_bf16 v31, v134, v4, v31
v_dot2_f32_bf16 v32, v138, v4, v32
v_dot2_f32_bf16 v33, v142, v4, v33
v_dot2_f32_bf16 v30, v131, v5, v30
v_dot2_f32_bf16 v31, v135, v5, v31
v_dot2_f32_bf16 v32, v139, v5, v32
v_dot2_f32_bf16 v33, v143, v5, v33
s_waitcnt vmcnt(5)
buffer_load_dwordx4 v[72:75], v1, s[36:39], s57 offen offset:2048 nt
s_waitcnt lgkmcnt(0)
v_dot2_f32_bf16 v34, v144, v2, 0
v_dot2_f32_bf16 v35, v148, v2, 0
v_dot2_f32_bf16 v36, v152, v2, 0
v_dot2_f32_bf16 v37, v156, v2, 0
v_dot2_f32_bf16 v34, v145, v3, v34
v_dot2_f32_bf16 v35, v149, v3, v35
v_dot2_f32_bf16 v36, v153, v3, v36
v_dot2_f32_bf16 v37, v157, v3, v37
v_dot2_f32_bf16 v34, v146, v4, v34
v_dot2_f32_bf16 v35, v150, v4, v35
v_dot2_f32_bf16 v36, v154, v4, v36
v_dot2_f32_bf16 v37, v158, v4, v37
v_dot2_f32_bf16 v34, v147, v5, v34
v_dot2_f32_bf16 v35, v151, v5, v35
v_dot2_f32_bf16 v36, v155, v5, v36
v_dot2_f32_bf16 v37, v159, v5, v37
s_waitcnt lgkmcnt(0)
v_dot2_f32_bf16 v38, v160, v2, 0
v_dot2_f32_bf16 v39, v164, v2, 0
v_dot2_f32_bf16 v40, v168, v2, 0
v_dot2_f32_bf16 v41, v172, v2, 0
v_dot2_f32_bf16 v38, v161, v3, v38
v_dot2_f32_bf16 v39, v165, v3, v39
v_dot2_f32_bf16 v40, v169, v3, v40
v_dot2_f32_bf16 v41, v173, v3, v41
v_dot2_f32_bf16 v38, v162, v4, v38
v_dot2_f32_bf16 v39, v166, v4, v39
v_dot2_f32_bf16 v40, v170, v4, v40
v_dot2_f32_bf16 v41, v174, v4, v41
v_dot2_f32_bf16 v38, v163, v5, v38
v_dot2_f32_bf16 v39, v167, v5, v39
v_dot2_f32_bf16 v40, v171, v5, v40
v_dot2_f32_bf16 v41, v175, v5, v41
s_waitcnt vmcnt(5)
buffer_load_dwordx4 v[76:79], v1, s[36:39], s57 offen offset:3072 nt
s_nop 2
v_add_f32_dpp v26, v26, v26 row_ror:8 row_mask:0xf bank_mask:0x3
v_add_f32_dpp v26, v34, v34 row_ror:8 row_mask:0xf bank_mask:0xc
v_add_f32_dpp v27, v27, v27 row_ror:8 row_mask:0xf bank_mask:0x3
v_add_f32_dpp v27, v35, v35 row_ror:8 row_mask:0xf bank_mask:0xc
v_add_f32_dpp v28, v28, v28 row_ror:8 row_mask:0xf bank_mask:0x3
v_add_f32_dpp v28, v36, v36 row_ror:8 row_mask:0xf bank_mask:0xc
v_add_f32_dpp v29, v29, v29 row_ror:8 row_mask:0xf bank_mask:0x3
v_add_f32_dpp v29, v37, v37 row_ror:8 row_mask:0xf bank_mask:0xc
v_add_f32_dpp v30, v30, v30 row_ror:8 row_mask:0xf bank_mask:0x3
v_add_f32_dpp v30, v38, v38 row_ror:8 row_mask:0xf bank_mask:0xc
v_add_f32_dpp v31, v31, v31 row_ror:8 row_mask:0xf bank_mask:0x3
v_add_f32_dpp v31, v39, v39 row_ror:8 row_mask:0xf bank_mask:0xc
v_add_f32_dpp v32, v32, v32 row_ror:8 row_mask:0xf bank_mask:0x3
v_add_f32_dpp v32, v40, v40 row_ror:8 row_mask:0xf bank_mask:0xc
v_add_f32_dpp v33, v33, v33 row_ror:8 row_mask:0xf bank_mask:0x3
v_add_f32_dpp v33, v41, v41 row_ror:8 row_mask:0xf bank_mask:0xc
v_add_f32_dpp v26, v26, v26 row_shl:4 row_mask:0xf bank_mask:0x5
v_add_f32_dpp v26, v30, v30 row_shr:4 row_mask:0xf bank_mask:0xa
v_add_f32_dpp v27, v27, v27 row_shl:4 row_mask:0xf bank_mask:0x5
v_add_f32_dpp v27, v31, v31 row_shr:4 row_mask:0xf bank_mask:0xa
v_add_f32_dpp v28, v28, v28 row_shl:4 row_mask:0xf bank_mask:0x5
v_add_f32_dpp v28, v32, v32 row_shr:4 row_mask:0xf bank_mask:0xa
v_add_f32_dpp v29, v29, v29 row_shl:4 row_mask:0xf bank_mask:0x5
v_add_f32_dpp v29, v33, v33 row_shr:4 row_mask:0xf bank_mask:0xa
s_nop 0
v_add_f32_dpp v26, v26, v26 quad_perm:[2,3,0,1] row_mask:0xf bank_mask:0xf
v_add_f32_dpp v27, v27, v27 quad_perm:[2,3,0,1] row_mask:0xf bank_mask:0xf
v_add_f32_dpp v28, v28, v28 quad_perm:[2,3,0,1] row_mask:0xf bank_mask:0xf
v_add_f32_dpp v29, v29, v29 quad_perm:[2,3,0,1] row_mask:0xf bank_mask:0xf
v_cndmask_b32 v26, v26, v28, s[60:61]
v_cndmask_b32 v27, v27, v29, s[60:61]
s_nop 1
v_add_f32_dpp v26, v26, v26 quad_perm:[1,0,3,2] row_mask:0xf bank_mask:0xf
v_add_f32_dpp v27, v27, v27 quad_perm:[1,0,3,2] row_mask:0xf bank_mask:0xf
v_cndmask_b32 v25, v26, v27, s[62:63]
v_max3_f32 v42, v22, v23, v24
v_max_f32 v42, v42, v25
s_nop 1
v_max_f32_dpp v42, v42, v42 row_ror:8 row_mask:0xf bank_mask:0xf
s_nop 1
v_max_f32_dpp v42, v42, v42 row_ror:4 row_mask:0xf bank_mask:0xf
s_nop 1
v_max_f32_dpp v42, v42, v42 row_ror:2 row_mask:0xf bank_mask:0xf
s_nop 1
v_max_f32_dpp v42, v42, v42 row_ror:1 row_mask:0xf bank_mask:0xf
s_nop 0
v_mov_b32 v43, v42
s_nop 1
v_permlane16_swap_b32 v42, v43
s_nop 1
v_max_f32 v42, v42, v43
s_nop 0
v_mov_b32 v43, v42
s_nop 1
v_permlane32_swap_b32 v42, v43
s_nop 1
v_max_f32 v42, v42, v43
v_mul_f32 v42, 0x3e0293ee, v42
s_mov_b32 s54, 0x3e0293ee
s_waitcnt vmcnt(5)
s_mov_b32 s57, 65536
buffer_load_dwordx4 v[80:83], v1, s[36:39], s57 offen offset:0 nt
v_fma_f32 v22, v22, s54, -v42
v_fma_f32 v23, v23, s54, -v42
v_fma_f32 v24, v24, s54, -v42
v_fma_f32 v25, v25, s54, -v42
v_exp_f32 v22, v22
v_exp_f32 v23, v23
v_exp_f32 v24, v24
v_exp_f32 v25, v25
s_nop 0
v_add_f32 v43, v22, v23
v_add_f32 v44, v24, v25
v_add_f32 v43, v43, v44
s_nop 1
v_add_f32_dpp v43, v43, v43 row_ror:8 row_mask:0xf bank_mask:0xf
s_nop 1
v_add_f32_dpp v43, v43, v43 row_ror:4 row_mask:0xf bank_mask:0xf
s_nop 1
v_add_f32_dpp v43, v43, v43 row_ror:2 row_mask:0xf bank_mask:0xf
s_nop 1
v_add_f32_dpp v43, v43, v43 row_ror:1 row_mask:0xf bank_mask:0xf
s_nop 0
v_mov_b32 v44, v43
s_nop 1
v_permlane16_swap_b32 v43, v44
s_nop 1
v_add_f32 v43, v43, v44
s_nop 0
v_mov_b32 v44, v43
s_nop 1
v_permlane32_swap_b32 v43, v44
s_nop 1
v_add_f32 v43, v43, v44
s_lshl_b32 s54, s3, 3
v_mov_b32 v44, s54
s_mov_b64 exec, 1
ds_write_b64 v44, v[42:43] offset:256
s_mov_b64 exec, -1
s_waitcnt lgkmcnt(0)
s_waitcnt vmcnt(5)
buffer_load_dwordx4 v[84:87], v1, s[36:39], s57 offen offset:1024 nt
s_barrier
v_mov_b32 v43, 0
ds_read_b128 v[26:29], v43 offset:256
ds_read_b128 v[30:33], v43 offset:272
s_waitcnt lgkmcnt(0)
v_max3_f32 v43, v26, v28, v30
v_max_f32 v43, v43, v32
v_sub_f32 v42, v42, v43
v_exp_f32 v42, v42
s_nop 0
v_mul_f32 v22, v22, v42
v_mul_f32 v23, v23, v42
v_mul_f32 v24, v24, v42
v_mul_f32 v25, v25, v42
v_cvt_pk_bf16_f32 v22, v22, v22
v_cvt_pk_bf16_f32 v23, v23, v23
v_cvt_pk_bf16_f32 v24, v24, v24
v_cvt_pk_bf16_f32 v25, v25, v25
v_lshrrev_b32 v34, 4, v0
v_lshlrev_b32 v34, 7, v34
v_and_b32 v43, 15, v0
v_lshlrev_b32 v43, 2, v43
v_add_u32 v34, v34, v43
s_lshl_b32 s66, s3, 9
v_add_u32 v34, s66, v34
v_lshlrev_b32 v35, 5, v0
v_lshlrev_b32 v36, 4, v0
s_lshl_b32 s66, s50, 3
s_add_u32 s66, s66, s51
s_lshl_b32 s66, s66, 8
s_add_u32 s66, s66, 458752
v_mov_b32 v43, 0
ds_read_b32 v43, v43 offset:404
s_waitcnt lgkmcnt(0)
v_readfirstlane_b32 s67, v43
s_mov_b32 s40, s28
s_mov_b32 s41, s29
s_mov_b32 s42, 1179648
s_mov_b32 s43, 0x20000
s_waitcnt vmcnt(17)
v_and_b32_dpp v14, v22, v6 row_newbcast:0 row_mask:0xf bank_mask:0xf
v_and_b32_dpp v15, v22, v7 row_newbcast:0 row_mask:0xf bank_mask:0xf
v_and_b32_dpp v16, v22, v8 row_newbcast:0 row_mask:0xf bank_mask:0xf
v_and_b32_dpp v17, v22, v9 row_newbcast:0 row_mask:0xf bank_mask:0xf
s_nop 1
v_mfma_f32_16x16x32_bf16 v[10:13], v[208:211], v[14:17], v[10:13]
s_waitcnt vmcnt(16)
v_and_b32_dpp v18, v22, v6 row_newbcast:1 row_mask:0xf bank_mask:0xf
v_and_b32_dpp v19, v22, v7 row_newbcast:1 row_mask:0xf bank_mask:0xf
v_and_b32_dpp v20, v22, v8 row_newbcast:1 row_mask:0xf bank_mask:0xf
v_and_b32_dpp v21, v22, v9 row_newbcast:1 row_mask:0xf bank_mask:0xf
s_nop 1
v_mfma_f32_16x16x32_bf16 v[10:13], v[212:215], v[18:21], v[10:13]
s_waitcnt vmcnt(15)
v_and_b32_dpp v14, v22, v6 row_newbcast:2 row_mask:0xf bank_mask:0xf
v_and_b32_dpp v15, v22, v7 row_newbcast:2 row_mask:0xf bank_mask:0xf
v_and_b32_dpp v16, v22, v8 row_newbcast:2 row_mask:0xf bank_mask:0xf
v_and_b32_dpp v17, v22, v9 row_newbcast:2 row_mask:0xf bank_mask:0xf
s_nop 1
v_mfma_f32_16x16x32_bf16 v[10:13], v[216:219], v[14:17], v[10:13]
s_waitcnt vmcnt(14)
v_and_b32_dpp v18, v22, v6 row_newbcast:3 row_mask:0xf bank_mask:0xf
v_and_b32_dpp v19, v22, v7 row_newbcast:3 row_mask:0xf bank_mask:0xf
v_and_b32_dpp v20, v22, v8 row_newbcast:3 row_mask:0xf bank_mask:0xf
v_and_b32_dpp v21, v22, v9 row_newbcast:3 row_mask:0xf bank_mask:0xf
s_nop 1
v_mfma_f32_16x16x32_bf16 v[10:13], v[220:223], v[18:21], v[10:13]
s_waitcnt vmcnt(13)
v_and_b32_dpp v14, v22, v6 row_newbcast:4 row_mask:0xf bank_mask:0xf
v_and_b32_dpp v15, v22, v7 row_newbcast:4 row_mask:0xf bank_mask:0xf
v_and_b32_dpp v16, v22, v8 row_newbcast:4 row_mask:0xf bank_mask:0xf
v_and_b32_dpp v17, v22, v9 row_newbcast:4 row_mask:0xf bank_mask:0xf
s_nop 1
v_mfma_f32_16x16x32_bf16 v[10:13], v[224:227], v[14:17], v[10:13]
s_waitcnt vmcnt(5)
buffer_load_dwordx4 v[88:91], v1, s[36:39], s57 offen offset:2048 nt
s_waitcnt vmcnt(13)
v_and_b32_dpp v18, v22, v6 row_newbcast:5 row_mask:0xf bank_mask:0xf
v_and_b32_dpp v19, v22, v7 row_newbcast:5 row_mask:0xf bank_mask:0xf
v_and_b32_dpp v20, v22, v8 row_newbcast:5 row_mask:0xf bank_mask:0xf
v_and_b32_dpp v21, v22, v9 row_newbcast:5 row_mask:0xf bank_mask:0xf
s_nop 1
v_mfma_f32_16x16x32_bf16 v[10:13], v[228:231], v[18:21], v[10:13]
s_waitcnt vmcnt(12)
v_and_b32_dpp v14, v22, v6 row_newbcast:6 row_mask:0xf bank_mask:0xf
v_and_b32_dpp v15, v22, v7 row_newbcast:6 row_mask:0xf bank_mask:0xf
v_and_b32_dpp v16, v22, v8 row_newbcast:6 row_mask:0xf bank_mask:0xf
v_and_b32_dpp v17, v22, v9 row_newbcast:6 row_mask:0xf bank_mask:0xf
s_nop 1
v_mfma_f32_16x16x32_bf16 v[10:13], v[232:235], v[14:17], v[10:13]
s_waitcnt vmcnt(11)
v_and_b32_dpp v18, v22, v6 row_newbcast:7 row_mask:0xf bank_mask:0xf
v_and_b32_dpp v19, v22, v7 row_newbcast:7 row_mask:0xf bank_mask:0xf
v_and_b32_dpp v20, v22, v8 row_newbcast:7 row_mask:0xf bank_mask:0xf
v_and_b32_dpp v21, v22, v9 row_newbcast:7 row_mask:0xf bank_mask:0xf
s_nop 1
v_mfma_f32_16x16x32_bf16 v[10:13], v[236:239], v[18:21], v[10:13]
s_waitcnt vmcnt(10)
v_and_b32_dpp v14, v22, v6 row_newbcast:8 row_mask:0xf bank_mask:0xf
v_and_b32_dpp v15, v22, v7 row_newbcast:8 row_mask:0xf bank_mask:0xf
v_and_b32_dpp v16, v22, v8 row_newbcast:8 row_mask:0xf bank_mask:0xf
v_and_b32_dpp v17, v22, v9 row_newbcast:8 row_mask:0xf bank_mask:0xf
s_nop 1
v_mfma_f32_16x16x32_bf16 v[10:13], v[48:51], v[14:17], v[10:13]
s_waitcnt vmcnt(9)
v_and_b32_dpp v18, v22, v6 row_newbcast:9 row_mask:0xf bank_mask:0xf
v_and_b32_dpp v19, v22, v7 row_newbcast:9 row_mask:0xf bank_mask:0xf
v_and_b32_dpp v20, v22, v8 row_newbcast:9 row_mask:0xf bank_mask:0xf
v_and_b32_dpp v21, v22, v9 row_newbcast:9 row_mask:0xf bank_mask:0xf
s_nop 1
v_mfma_f32_16x16x32_bf16 v[10:13], v[52:55], v[18:21], v[10:13]
s_waitcnt vmcnt(5)
buffer_load_dwordx4 v[92:95], v1, s[36:39], s57 offen offset:3072 nt
s_waitcnt vmcnt(9)
v_and_b32_dpp v14, v22, v6 row_newbcast:10 row_mask:0xf bank_mask:0xf
v_and_b32_dpp v15, v22, v7 row_newbcast:10 row_mask:0xf bank_mask:0xf
v_and_b32_dpp v16, v22, v8 row_newbcast:10 row_mask:0xf bank_mask:0xf
v_and_b32_dpp v17, v22, v9 row_newbcast:10 row_mask:0xf bank_mask:0xf
s_nop 1
v_mfma_f32_16x16x32_bf16 v[10:13], v[56:59], v[14:17], v[10:13]
s_waitcnt vmcnt(8)
v_and_b32_dpp v18, v22, v6 row_newbcast:11 row_mask:0xf bank_mask:0xf
v_and_b32_dpp v19, v22, v7 row_newbcast:11 row_mask:0xf bank_mask:0xf
v_and_b32_dpp v20, v22, v8 row_newbcast:11 row_mask:0xf bank_mask:0xf
v_and_b32_dpp v21, v22, v9 row_newbcast:11 row_mask:0xf bank_mask:0xf
s_nop 1
v_mfma_f32_16x16x32_bf16 v[10:13], v[60:63], v[18:21], v[10:13]
s_waitcnt vmcnt(7)
v_and_b32_dpp v14, v22, v6 row_newbcast:12 row_mask:0xf bank_mask:0xf
v_and_b32_dpp v15, v22, v7 row_newbcast:12 row_mask:0xf bank_mask:0xf
v_and_b32_dpp v16, v22, v8 row_newbcast:12 row_mask:0xf bank_mask:0xf
v_and_b32_dpp v17, v22, v9 row_newbcast:12 row_mask:0xf bank_mask:0xf
s_nop 1
v_mfma_f32_16x16x32_bf16 v[10:13], v[64:67], v[14:17], v[10:13]
s_waitcnt vmcnt(6)
v_and_b32_dpp v18, v22, v6 row_newbcast:13 row_mask:0xf bank_mask:0xf
v_and_b32_dpp v19, v22, v7 row_newbcast:13 row_mask:0xf bank_mask:0xf
v_and_b32_dpp v20, v22, v8 row_newbcast:13 row_mask:0xf bank_mask:0xf
v_and_b32_dpp v21, v22, v9 row_newbcast:13 row_mask:0xf bank_mask:0xf
s_nop 1
v_mfma_f32_16x16x32_bf16 v[10:13], v[68:71], v[18:21], v[10:13]
s_waitcnt vmcnt(5)
v_and_b32_dpp v14, v22, v6 row_newbcast:14 row_mask:0xf bank_mask:0xf
v_and_b32_dpp v15, v22, v7 row_newbcast:14 row_mask:0xf bank_mask:0xf
v_and_b32_dpp v16, v22, v8 row_newbcast:14 row_mask:0xf bank_mask:0xf
v_and_b32_dpp v17, v22, v9 row_newbcast:14 row_mask:0xf bank_mask:0xf
s_nop 1
v_mfma_f32_16x16x32_bf16 v[10:13], v[72:75], v[14:17], v[10:13]
s_waitcnt vmcnt(5)
s_mov_b32 s57, 81920
buffer_load_dwordx4 v[96:99], v1, s[36:39], s57 offen offset:0 nt
s_waitcnt vmcnt(5)
v_and_b32_dpp v18, v22, v6 row_newbcast:15 row_mask:0xf bank_mask:0xf
v_and_b32_dpp v19, v22, v7 row_newbcast:15 row_mask:0xf bank_mask:0xf
v_and_b32_dpp v20, v22, v8 row_newbcast:15 row_mask:0xf bank_mask:0xf
v_and_b32_dpp v21, v22, v9 row_newbcast:15 row_mask:0xf bank_mask:0xf
s_nop 1
v_mfma_f32_16x16x32_bf16 v[10:13], v[76:79], v[18:21], v[10:13]
s_waitcnt vmcnt(5)
buffer_load_dwordx4 v[100:103], v1, s[36:39], s57 offen offset:1024 nt
s_waitcnt vmcnt(5)
v_and_b32_dpp v14, v23, v6 row_newbcast:0 row_mask:0xf bank_mask:0xf
v_and_b32_dpp v15, v23, v7 row_newbcast:0 row_mask:0xf bank_mask:0xf
v_and_b32_dpp v16, v23, v8 row_newbcast:0 row_mask:0xf bank_mask:0xf
v_and_b32_dpp v17, v23, v9 row_newbcast:0 row_mask:0xf bank_mask:0xf
s_nop 1
v_mfma_f32_16x16x32_bf16 v[10:13], v[80:83], v[14:17], v[10:13]
s_waitcnt vmcnt(5)
buffer_load_dwordx4 v[104:107], v1, s[36:39], s57 offen offset:2048 nt
s_waitcnt vmcnt(5)
v_and_b32_dpp v18, v23, v6 row_newbcast:1 row_mask:0xf bank_mask:0xf
v_and_b32_dpp v19, v23, v7 row_newbcast:1 row_mask:0xf bank_mask:0xf
v_and_b32_dpp v20, v23, v8 row_newbcast:1 row_mask:0xf bank_mask:0xf
v_and_b32_dpp v21, v23, v9 row_newbcast:1 row_mask:0xf bank_mask:0xf
s_nop 1
v_mfma_f32_16x16x32_bf16 v[10:13], v[84:87], v[18:21], v[10:13]
s_waitcnt vmcnt(5)
buffer_load_dwordx4 v[108:111], v1, s[36:39], s57 offen offset:3072 nt
s_waitcnt vmcnt(5)
v_and_b32_dpp v14, v23, v6 row_newbcast:2 row_mask:0xf bank_mask:0xf
v_and_b32_dpp v15, v23, v7 row_newbcast:2 row_mask:0xf bank_mask:0xf
v_and_b32_dpp v16, v23, v8 row_newbcast:2 row_mask:0xf bank_mask:0xf
v_and_b32_dpp v17, v23, v9 row_newbcast:2 row_mask:0xf bank_mask:0xf
s_nop 1
v_mfma_f32_16x16x32_bf16 v[10:13], v[88:91], v[14:17], v[10:13]
s_waitcnt vmcnt(5)
s_mov_b32 s57, 98304
buffer_load_dwordx4 v[112:115], v1, s[36:39], s57 offen offset:0 nt
s_waitcnt vmcnt(5)
v_and_b32_dpp v18, v23, v6 row_newbcast:3 row_mask:0xf bank_mask:0xf
v_and_b32_dpp v19, v23, v7 row_newbcast:3 row_mask:0xf bank_mask:0xf
v_and_b32_dpp v20, v23, v8 row_newbcast:3 row_mask:0xf bank_mask:0xf
v_and_b32_dpp v21, v23, v9 row_newbcast:3 row_mask:0xf bank_mask:0xf
s_nop 1
v_mfma_f32_16x16x32_bf16 v[10:13], v[92:95], v[18:21], v[10:13]
s_waitcnt vmcnt(5)
buffer_load_dwordx4 v[116:119], v1, s[36:39], s57 offen offset:1024 nt
s_waitcnt vmcnt(5)
v_and_b32_dpp v14, v23, v6 row_newbcast:4 row_mask:0xf bank_mask:0xf
v_and_b32_dpp v15, v23, v7 row_newbcast:4 row_mask:0xf bank_mask:0xf
v_and_b32_dpp v16, v23, v8 row_newbcast:4 row_mask:0xf bank_mask:0xf
v_and_b32_dpp v17, v23, v9 row_newbcast:4 row_mask:0xf bank_mask:0xf
s_nop 1
v_mfma_f32_16x16x32_bf16 v[10:13], v[96:99], v[14:17], v[10:13]
s_waitcnt vmcnt(5)
buffer_load_dwordx4 v[120:123], v1, s[36:39], s57 offen offset:2048 nt
s_waitcnt vmcnt(5)
v_and_b32_dpp v18, v23, v6 row_newbcast:5 row_mask:0xf bank_mask:0xf
v_and_b32_dpp v19, v23, v7 row_newbcast:5 row_mask:0xf bank_mask:0xf
v_and_b32_dpp v20, v23, v8 row_newbcast:5 row_mask:0xf bank_mask:0xf
v_and_b32_dpp v21, v23, v9 row_newbcast:5 row_mask:0xf bank_mask:0xf
s_nop 1
v_mfma_f32_16x16x32_bf16 v[10:13], v[100:103], v[18:21], v[10:13]
s_waitcnt vmcnt(5)
buffer_load_dwordx4 v[124:127], v1, s[36:39], s57 offen offset:3072 nt
s_waitcnt vmcnt(5)
v_and_b32_dpp v14, v23, v6 row_newbcast:6 row_mask:0xf bank_mask:0xf
v_and_b32_dpp v15, v23, v7 row_newbcast:6 row_mask:0xf bank_mask:0xf
v_and_b32_dpp v16, v23, v8 row_newbcast:6 row_mask:0xf bank_mask:0xf
v_and_b32_dpp v17, v23, v9 row_newbcast:6 row_mask:0xf bank_mask:0xf
s_nop 1
v_mfma_f32_16x16x32_bf16 v[10:13], v[104:107], v[14:17], v[10:13]
s_waitcnt vmcnt(5)
s_mov_b32 s57, 114688
buffer_load_dwordx4 v[128:131], v1, s[36:39], s57 offen offset:0 nt
s_waitcnt vmcnt(5)
v_and_b32_dpp v18, v23, v6 row_newbcast:7 row_mask:0xf bank_mask:0xf
v_and_b32_dpp v19, v23, v7 row_newbcast:7 row_mask:0xf bank_mask:0xf
v_and_b32_dpp v20, v23, v8 row_newbcast:7 row_mask:0xf bank_mask:0xf
v_and_b32_dpp v21, v23, v9 row_newbcast:7 row_mask:0xf bank_mask:0xf
s_nop 1
v_mfma_f32_16x16x32_bf16 v[10:13], v[108:111], v[18:21], v[10:13]
s_waitcnt vmcnt(5)
buffer_load_dwordx4 v[132:135], v1, s[36:39], s57 offen offset:1024 nt
s_mov_b64 exec, 1
v_mov_b32 v43, 0
v_mov_b32 v44, 1
ds_add_u32 v43, v44 offset:408
s_mov_b64 exec, -1
s_waitcnt vmcnt(5)
v_and_b32_dpp v14, v23, v6 row_newbcast:8 row_mask:0xf bank_mask:0xf
v_and_b32_dpp v15, v23, v7 row_newbcast:8 row_mask:0xf bank_mask:0xf
v_and_b32_dpp v16, v23, v8 row_newbcast:8 row_mask:0xf bank_mask:0xf
v_and_b32_dpp v17, v23, v9 row_newbcast:8 row_mask:0xf bank_mask:0xf
s_nop 1
v_mfma_f32_16x16x32_bf16 v[10:13], v[112:115], v[14:17], v[10:13]
s_waitcnt vmcnt(5)
buffer_load_dwordx4 v[136:139], v1, s[36:39], s57 offen offset:2048 nt
s_waitcnt vmcnt(5)
v_and_b32_dpp v18, v23, v6 row_newbcast:9 row_mask:0xf bank_mask:0xf
v_and_b32_dpp v19, v23, v7 row_newbcast:9 row_mask:0xf bank_mask:0xf
v_and_b32_dpp v20, v23, v8 row_newbcast:9 row_mask:0xf bank_mask:0xf
v_and_b32_dpp v21, v23, v9 row_newbcast:9 row_mask:0xf bank_mask:0xf
s_nop 1
v_mfma_f32_16x16x32_bf16 v[10:13], v[116:119], v[18:21], v[10:13]
s_waitcnt vmcnt(5)
buffer_load_dwordx4 v[140:143], v1, s[36:39], s57 offen offset:3072 nt
s_waitcnt vmcnt(5)
v_and_b32_dpp v14, v23, v6 row_newbcast:10 row_mask:0xf bank_mask:0xf
v_and_b32_dpp v15, v23, v7 row_newbcast:10 row_mask:0xf bank_mask:0xf
v_and_b32_dpp v16, v23, v8 row_newbcast:10 row_mask:0xf bank_mask:0xf
v_and_b32_dpp v17, v23, v9 row_newbcast:10 row_mask:0xf bank_mask:0xf
s_nop 1
v_mfma_f32_16x16x32_bf16 v[10:13], v[120:123], v[14:17], v[10:13]
s_waitcnt vmcnt(5)
s_mov_b32 s57, 131072
buffer_load_dwordx4 v[144:147], v1, s[36:39], s57 offen offset:0 nt
s_waitcnt vmcnt(5)
v_and_b32_dpp v18, v23, v6 row_newbcast:11 row_mask:0xf bank_mask:0xf
v_and_b32_dpp v19, v23, v7 row_newbcast:11 row_mask:0xf bank_mask:0xf
v_and_b32_dpp v20, v23, v8 row_newbcast:11 row_mask:0xf bank_mask:0xf
v_and_b32_dpp v21, v23, v9 row_newbcast:11 row_mask:0xf bank_mask:0xf
s_nop 1
v_mfma_f32_16x16x32_bf16 v[10:13], v[124:127], v[18:21], v[10:13]
s_waitcnt vmcnt(5)
buffer_load_dwordx4 v[148:151], v1, s[36:39], s57 offen offset:1024 nt
s_waitcnt vmcnt(5)
v_and_b32_dpp v14, v23, v6 row_newbcast:12 row_mask:0xf bank_mask:0xf
v_and_b32_dpp v15, v23, v7 row_newbcast:12 row_mask:0xf bank_mask:0xf
v_and_b32_dpp v16, v23, v8 row_newbcast:12 row_mask:0xf bank_mask:0xf
v_and_b32_dpp v17, v23, v9 row_newbcast:12 row_mask:0xf bank_mask:0xf
s_nop 1
v_mfma_f32_16x16x32_bf16 v[10:13], v[128:131], v[14:17], v[10:13]
s_waitcnt vmcnt(5)
buffer_load_dwordx4 v[152:155], v1, s[36:39], s57 offen offset:2048 nt
s_waitcnt vmcnt(5)
v_and_b32_dpp v18, v23, v6 row_newbcast:13 row_mask:0xf bank_mask:0xf
v_and_b32_dpp v19, v23, v7 row_newbcast:13 row_mask:0xf bank_mask:0xf
v_and_b32_dpp v20, v23, v8 row_newbcast:13 row_mask:0xf bank_mask:0xf
v_and_b32_dpp v21, v23, v9 row_newbcast:13 row_mask:0xf bank_mask:0xf
s_nop 1
v_mfma_f32_16x16x32_bf16 v[10:13], v[132:135], v[18:21], v[10:13]
s_waitcnt vmcnt(5)
buffer_load_dwordx4 v[156:159], v1, s[36:39], s57 offen offset:3072 nt
s_waitcnt vmcnt(5)
v_and_b32_dpp v14, v23, v6 row_newbcast:14 row_mask:0xf bank_mask:0xf
v_and_b32_dpp v15, v23, v7 row_newbcast:14 row_mask:0xf bank_mask:0xf
v_and_b32_dpp v16, v23, v8 row_newbcast:14 row_mask:0xf bank_mask:0xf
v_and_b32_dpp v17, v23, v9 row_newbcast:14 row_mask:0xf bank_mask:0xf
s_nop 1
v_mfma_f32_16x16x32_bf16 v[10:13], v[136:139], v[14:17], v[10:13]
s_waitcnt vmcnt(5)
s_mov_b32 s57, 147456
buffer_load_dwordx4 v[160:163], v1, s[36:39], s57 offen offset:0 nt
s_waitcnt vmcnt(5)
v_and_b32_dpp v18, v23, v6 row_newbcast:15 row_mask:0xf bank_mask:0xf
v_and_b32_dpp v19, v23, v7 row_newbcast:15 row_mask:0xf bank_mask:0xf
v_and_b32_dpp v20, v23, v8 row_newbcast:15 row_mask:0xf bank_mask:0xf
v_and_b32_dpp v21, v23, v9 row_newbcast:15 row_mask:0xf bank_mask:0xf
s_nop 1
v_mfma_f32_16x16x32_bf16 v[10:13], v[140:143], v[18:21], v[10:13]
s_waitcnt vmcnt(5)
buffer_load_dwordx4 v[164:167], v1, s[36:39], s57 offen offset:1024 nt
s_waitcnt vmcnt(5)
v_and_b32_dpp v14, v24, v6 row_newbcast:0 row_mask:0xf bank_mask:0xf
v_and_b32_dpp v15, v24, v7 row_newbcast:0 row_mask:0xf bank_mask:0xf
v_and_b32_dpp v16, v24, v8 row_newbcast:0 row_mask:0xf bank_mask:0xf
v_and_b32_dpp v17, v24, v9 row_newbcast:0 row_mask:0xf bank_mask:0xf
s_nop 1
v_mfma_f32_16x16x32_bf16 v[10:13], v[144:147], v[14:17], v[10:13]
s_waitcnt vmcnt(5)
buffer_load_dwordx4 v[168:171], v1, s[36:39], s57 offen offset:2048 nt
s_waitcnt vmcnt(5)
v_and_b32_dpp v18, v24, v6 row_newbcast:1 row_mask:0xf bank_mask:0xf
v_and_b32_dpp v19, v24, v7 row_newbcast:1 row_mask:0xf bank_mask:0xf
v_and_b32_dpp v20, v24, v8 row_newbcast:1 row_mask:0xf bank_mask:0xf
v_and_b32_dpp v21, v24, v9 row_newbcast:1 row_mask:0xf bank_mask:0xf
s_nop 1
v_mfma_f32_16x16x32_bf16 v[10:13], v[148:151], v[18:21], v[10:13]
s_waitcnt vmcnt(5)
buffer_load_dwordx4 v[172:175], v1, s[36:39], s57 offen offset:3072 nt
s_waitcnt vmcnt(5)
v_and_b32_dpp v14, v24, v6 row_newbcast:2 row_mask:0xf bank_mask:0xf
v_and_b32_dpp v15, v24, v7 row_newbcast:2 row_mask:0xf bank_mask:0xf
v_and_b32_dpp v16, v24, v8 row_newbcast:2 row_mask:0xf bank_mask:0xf
v_and_b32_dpp v17, v24, v9 row_newbcast:2 row_mask:0xf bank_mask:0xf
s_nop 1
v_mfma_f32_16x16x32_bf16 v[10:13], v[152:155], v[14:17], v[10:13]
s_waitcnt vmcnt(5)
s_mov_b32 s57, 163840
buffer_load_dwordx4 v[176:179], v1, s[36:39], s57 offen offset:0 nt
s_waitcnt vmcnt(5)
v_and_b32_dpp v18, v24, v6 row_newbcast:3 row_mask:0xf bank_mask:0xf
v_and_b32_dpp v19, v24, v7 row_newbcast:3 row_mask:0xf bank_mask:0xf
v_and_b32_dpp v20, v24, v8 row_newbcast:3 row_mask:0xf bank_mask:0xf
v_and_b32_dpp v21, v24, v9 row_newbcast:3 row_mask:0xf bank_mask:0xf
s_nop 1
v_mfma_f32_16x16x32_bf16 v[10:13], v[156:159], v[18:21], v[10:13]
s_waitcnt vmcnt(5)
buffer_load_dwordx4 v[180:183], v1, s[36:39], s57 offen offset:1024 nt
s_waitcnt vmcnt(5)
v_and_b32_dpp v14, v24, v6 row_newbcast:4 row_mask:0xf bank_mask:0xf
v_and_b32_dpp v15, v24, v7 row_newbcast:4 row_mask:0xf bank_mask:0xf
v_and_b32_dpp v16, v24, v8 row_newbcast:4 row_mask:0xf bank_mask:0xf
v_and_b32_dpp v17, v24, v9 row_newbcast:4 row_mask:0xf bank_mask:0xf
s_nop 1
v_mfma_f32_16x16x32_bf16 v[10:13], v[160:163], v[14:17], v[10:13]
s_waitcnt vmcnt(5)
buffer_load_dwordx4 v[184:187], v1, s[36:39], s57 offen offset:2048 nt
s_waitcnt vmcnt(5)
v_and_b32_dpp v18, v24, v6 row_newbcast:5 row_mask:0xf bank_mask:0xf
v_and_b32_dpp v19, v24, v7 row_newbcast:5 row_mask:0xf bank_mask:0xf
v_and_b32_dpp v20, v24, v8 row_newbcast:5 row_mask:0xf bank_mask:0xf
v_and_b32_dpp v21, v24, v9 row_newbcast:5 row_mask:0xf bank_mask:0xf
s_nop 1
v_mfma_f32_16x16x32_bf16 v[10:13], v[164:167], v[18:21], v[10:13]
s_waitcnt vmcnt(5)
buffer_load_dwordx4 v[188:191], v1, s[36:39], s57 offen offset:3072 nt
s_waitcnt vmcnt(5)
v_and_b32_dpp v14, v24, v6 row_newbcast:6 row_mask:0xf bank_mask:0xf
v_and_b32_dpp v15, v24, v7 row_newbcast:6 row_mask:0xf bank_mask:0xf
v_and_b32_dpp v16, v24, v8 row_newbcast:6 row_mask:0xf bank_mask:0xf
v_and_b32_dpp v17, v24, v9 row_newbcast:6 row_mask:0xf bank_mask:0xf
s_nop 1
v_mfma_f32_16x16x32_bf16 v[10:13], v[168:171], v[14:17], v[10:13]
s_waitcnt vmcnt(5)
s_mov_b32 s57, 180224
buffer_load_dwordx4 v[192:195], v1, s[36:39], s57 offen offset:0 nt
s_waitcnt vmcnt(5)
v_and_b32_dpp v18, v24, v6 row_newbcast:7 row_mask:0xf bank_mask:0xf
v_and_b32_dpp v19, v24, v7 row_newbcast:7 row_mask:0xf bank_mask:0xf
v_and_b32_dpp v20, v24, v8 row_newbcast:7 row_mask:0xf bank_mask:0xf
v_and_b32_dpp v21, v24, v9 row_newbcast:7 row_mask:0xf bank_mask:0xf
s_nop 1
v_mfma_f32_16x16x32_bf16 v[10:13], v[172:175], v[18:21], v[10:13]
s_waitcnt vmcnt(5)
buffer_load_dwordx4 v[196:199], v1, s[36:39], s57 offen offset:1024 nt
s_waitcnt vmcnt(5)
v_and_b32_dpp v14, v24, v6 row_newbcast:8 row_mask:0xf bank_mask:0xf
v_and_b32_dpp v15, v24, v7 row_newbcast:8 row_mask:0xf bank_mask:0xf
v_and_b32_dpp v16, v24, v8 row_newbcast:8 row_mask:0xf bank_mask:0xf
v_and_b32_dpp v17, v24, v9 row_newbcast:8 row_mask:0xf bank_mask:0xf
s_nop 1
v_mfma_f32_16x16x32_bf16 v[10:13], v[176:179], v[14:17], v[10:13]
s_waitcnt vmcnt(5)
buffer_load_dwordx4 v[200:203], v1, s[36:39], s57 offen offset:2048 nt
s_waitcnt vmcnt(5)
v_and_b32_dpp v18, v24, v6 row_newbcast:9 row_mask:0xf bank_mask:0xf
v_and_b32_dpp v19, v24, v7 row_newbcast:9 row_mask:0xf bank_mask:0xf
v_and_b32_dpp v20, v24, v8 row_newbcast:9 row_mask:0xf bank_mask:0xf
v_and_b32_dpp v21, v24, v9 row_newbcast:9 row_mask:0xf bank_mask:0xf
s_nop 1
v_mfma_f32_16x16x32_bf16 v[10:13], v[180:183], v[18:21], v[10:13]
s_waitcnt vmcnt(5)
buffer_load_dwordx4 v[204:207], v1, s[36:39], s57 offen offset:3072 nt
s_waitcnt vmcnt(5)
v_and_b32_dpp v14, v24, v6 row_newbcast:10 row_mask:0xf bank_mask:0xf
v_and_b32_dpp v15, v24, v7 row_newbcast:10 row_mask:0xf bank_mask:0xf
v_and_b32_dpp v16, v24, v8 row_newbcast:10 row_mask:0xf bank_mask:0xf
v_and_b32_dpp v17, v24, v9 row_newbcast:10 row_mask:0xf bank_mask:0xf
s_nop 1
v_mfma_f32_16x16x32_bf16 v[10:13], v[184:187], v[14:17], v[10:13]
s_waitcnt vmcnt(5)
s_mov_b32 s57, 196608
buffer_load_dwordx4 v[208:211], v1, s[36:39], s57 offen offset:0 nt
s_waitcnt vmcnt(5)
v_and_b32_dpp v18, v24, v6 row_newbcast:11 row_mask:0xf bank_mask:0xf
v_and_b32_dpp v19, v24, v7 row_newbcast:11 row_mask:0xf bank_mask:0xf
v_and_b32_dpp v20, v24, v8 row_newbcast:11 row_mask:0xf bank_mask:0xf
v_and_b32_dpp v21, v24, v9 row_newbcast:11 row_mask:0xf bank_mask:0xf
s_nop 1
v_mfma_f32_16x16x32_bf16 v[10:13], v[188:191], v[18:21], v[10:13]
s_waitcnt vmcnt(5)
buffer_load_dwordx4 v[212:215], v1, s[36:39], s57 offen offset:1024 nt
s_waitcnt vmcnt(5)
v_and_b32_dpp v14, v24, v6 row_newbcast:12 row_mask:0xf bank_mask:0xf
v_and_b32_dpp v15, v24, v7 row_newbcast:12 row_mask:0xf bank_mask:0xf
v_and_b32_dpp v16, v24, v8 row_newbcast:12 row_mask:0xf bank_mask:0xf
v_and_b32_dpp v17, v24, v9 row_newbcast:12 row_mask:0xf bank_mask:0xf
s_nop 1
v_mfma_f32_16x16x32_bf16 v[10:13], v[192:195], v[14:17], v[10:13]
s_waitcnt vmcnt(5)
buffer_load_dwordx4 v[216:219], v1, s[36:39], s57 offen offset:2048 nt
s_waitcnt vmcnt(5)
v_and_b32_dpp v18, v24, v6 row_newbcast:13 row_mask:0xf bank_mask:0xf
v_and_b32_dpp v19, v24, v7 row_newbcast:13 row_mask:0xf bank_mask:0xf
v_and_b32_dpp v20, v24, v8 row_newbcast:13 row_mask:0xf bank_mask:0xf
v_and_b32_dpp v21, v24, v9 row_newbcast:13 row_mask:0xf bank_mask:0xf
s_nop 1
v_mfma_f32_16x16x32_bf16 v[10:13], v[196:199], v[18:21], v[10:13]
s_waitcnt vmcnt(5)
buffer_load_dwordx4 v[220:223], v1, s[36:39], s57 offen offset:3072 nt
s_waitcnt vmcnt(5)
v_and_b32_dpp v14, v24, v6 row_newbcast:14 row_mask:0xf bank_mask:0xf
v_and_b32_dpp v15, v24, v7 row_newbcast:14 row_mask:0xf bank_mask:0xf
v_and_b32_dpp v16, v24, v8 row_newbcast:14 row_mask:0xf bank_mask:0xf
v_and_b32_dpp v17, v24, v9 row_newbcast:14 row_mask:0xf bank_mask:0xf
s_nop 1
v_mfma_f32_16x16x32_bf16 v[10:13], v[200:203], v[14:17], v[10:13]
s_waitcnt vmcnt(5)
s_mov_b32 s57, 212992
buffer_load_dwordx4 v[224:227], v1, s[36:39], s57 offen offset:0 nt
s_waitcnt vmcnt(5)
v_and_b32_dpp v18, v24, v6 row_newbcast:15 row_mask:0xf bank_mask:0xf
v_and_b32_dpp v19, v24, v7 row_newbcast:15 row_mask:0xf bank_mask:0xf
v_and_b32_dpp v20, v24, v8 row_newbcast:15 row_mask:0xf bank_mask:0xf
v_and_b32_dpp v21, v24, v9 row_newbcast:15 row_mask:0xf bank_mask:0xf
s_nop 1
v_mfma_f32_16x16x32_bf16 v[10:13], v[204:207], v[18:21], v[10:13]
s_waitcnt vmcnt(5)
buffer_load_dwordx4 v[228:231], v1, s[36:39], s57 offen offset:1024 nt
s_waitcnt vmcnt(5)
v_and_b32_dpp v14, v25, v6 row_newbcast:0 row_mask:0xf bank_mask:0xf
v_and_b32_dpp v15, v25, v7 row_newbcast:0 row_mask:0xf bank_mask:0xf
v_and_b32_dpp v16, v25, v8 row_newbcast:0 row_mask:0xf bank_mask:0xf
v_and_b32_dpp v17, v25, v9 row_newbcast:0 row_mask:0xf bank_mask:0xf
s_nop 1
v_mfma_f32_16x16x32_bf16 v[10:13], v[208:211], v[14:17], v[10:13]
s_waitcnt vmcnt(5)
buffer_load_dwordx4 v[232:235], v1, s[36:39], s57 offen offset:2048 nt
s_waitcnt vmcnt(5)
v_and_b32_dpp v18, v25, v6 row_newbcast:1 row_mask:0xf bank_mask:0xf
v_and_b32_dpp v19, v25, v7 row_newbcast:1 row_mask:0xf bank_mask:0xf
v_and_b32_dpp v20, v25, v8 row_newbcast:1 row_mask:0xf bank_mask:0xf
v_and_b32_dpp v21, v25, v9 row_newbcast:1 row_mask:0xf bank_mask:0xf
s_nop 1
v_mfma_f32_16x16x32_bf16 v[10:13], v[212:215], v[18:21], v[10:13]
s_waitcnt vmcnt(5)
buffer_load_dwordx4 v[236:239], v1, s[36:39], s57 offen offset:3072 nt
s_waitcnt vmcnt(5)
v_and_b32_dpp v14, v25, v6 row_newbcast:2 row_mask:0xf bank_mask:0xf
v_and_b32_dpp v15, v25, v7 row_newbcast:2 row_mask:0xf bank_mask:0xf
v_and_b32_dpp v16, v25, v8 row_newbcast:2 row_mask:0xf bank_mask:0xf
v_and_b32_dpp v17, v25, v9 row_newbcast:2 row_mask:0xf bank_mask:0xf
s_nop 1
v_mfma_f32_16x16x32_bf16 v[10:13], v[216:219], v[14:17], v[10:13]
s_waitcnt vmcnt(5)
s_mov_b32 s57, 229376
buffer_load_dwordx4 v[48:51], v1, s[36:39], s57 offen offset:0 nt
s_waitcnt vmcnt(5)
v_and_b32_dpp v18, v25, v6 row_newbcast:3 row_mask:0xf bank_mask:0xf
v_and_b32_dpp v19, v25, v7 row_newbcast:3 row_mask:0xf bank_mask:0xf
v_and_b32_dpp v20, v25, v8 row_newbcast:3 row_mask:0xf bank_mask:0xf
v_and_b32_dpp v21, v25, v9 row_newbcast:3 row_mask:0xf bank_mask:0xf
s_nop 1
v_mfma_f32_16x16x32_bf16 v[10:13], v[220:223], v[18:21], v[10:13]
s_waitcnt vmcnt(5)
buffer_load_dwordx4 v[52:55], v1, s[36:39], s57 offen offset:1024 nt
s_waitcnt vmcnt(5)
v_and_b32_dpp v14, v25, v6 row_newbcast:4 row_mask:0xf bank_mask:0xf
v_and_b32_dpp v15, v25, v7 row_newbcast:4 row_mask:0xf bank_mask:0xf
v_and_b32_dpp v16, v25, v8 row_newbcast:4 row_mask:0xf bank_mask:0xf
v_and_b32_dpp v17, v25, v9 row_newbcast:4 row_mask:0xf bank_mask:0xf
s_nop 1
v_mfma_f32_16x16x32_bf16 v[10:13], v[224:227], v[14:17], v[10:13]
s_waitcnt vmcnt(5)
buffer_load_dwordx4 v[56:59], v1, s[36:39], s57 offen offset:2048 nt
s_waitcnt vmcnt(5)
v_and_b32_dpp v18, v25, v6 row_newbcast:5 row_mask:0xf bank_mask:0xf
v_and_b32_dpp v19, v25, v7 row_newbcast:5 row_mask:0xf bank_mask:0xf
v_and_b32_dpp v20, v25, v8 row_newbcast:5 row_mask:0xf bank_mask:0xf
v_and_b32_dpp v21, v25, v9 row_newbcast:5 row_mask:0xf bank_mask:0xf
s_nop 1
v_mfma_f32_16x16x32_bf16 v[10:13], v[228:231], v[18:21], v[10:13]
s_waitcnt vmcnt(5)
buffer_load_dwordx4 v[60:63], v1, s[36:39], s57 offen offset:3072 nt
s_waitcnt vmcnt(5)
v_and_b32_dpp v14, v25, v6 row_newbcast:6 row_mask:0xf bank_mask:0xf
v_and_b32_dpp v15, v25, v7 row_newbcast:6 row_mask:0xf bank_mask:0xf
v_and_b32_dpp v16, v25, v8 row_newbcast:6 row_mask:0xf bank_mask:0xf
v_and_b32_dpp v17, v25, v9 row_newbcast:6 row_mask:0xf bank_mask:0xf
s_nop 1
v_mfma_f32_16x16x32_bf16 v[10:13], v[232:235], v[14:17], v[10:13]
s_waitcnt vmcnt(5)
s_mov_b32 s57, 245760
buffer_load_dwordx4 v[64:67], v1, s[36:39], s57 offen offset:0 nt
s_waitcnt vmcnt(5)
v_and_b32_dpp v18, v25, v6 row_newbcast:7 row_mask:0xf bank_mask:0xf
v_and_b32_dpp v19, v25, v7 row_newbcast:7 row_mask:0xf bank_mask:0xf
v_and_b32_dpp v20, v25, v8 row_newbcast:7 row_mask:0xf bank_mask:0xf
v_and_b32_dpp v21, v25, v9 row_newbcast:7 row_mask:0xf bank_mask:0xf
s_nop 1
v_mfma_f32_16x16x32_bf16 v[10:13], v[236:239], v[18:21], v[10:13]
s_waitcnt vmcnt(5)
buffer_load_dwordx4 v[68:71], v1, s[36:39], s57 offen offset:1024 nt
s_waitcnt vmcnt(5)
v_and_b32_dpp v14, v25, v6 row_newbcast:8 row_mask:0xf bank_mask:0xf
v_and_b32_dpp v15, v25, v7 row_newbcast:8 row_mask:0xf bank_mask:0xf
v_and_b32_dpp v16, v25, v8 row_newbcast:8 row_mask:0xf bank_mask:0xf
v_and_b32_dpp v17, v25, v9 row_newbcast:8 row_mask:0xf bank_mask:0xf
s_nop 1
v_mfma_f32_16x16x32_bf16 v[10:13], v[48:51], v[14:17], v[10:13]
s_waitcnt vmcnt(5)
buffer_load_dwordx4 v[72:75], v1, s[36:39], s57 offen offset:2048 nt
s_waitcnt vmcnt(5)
v_and_b32_dpp v18, v25, v6 row_newbcast:9 row_mask:0xf bank_mask:0xf
v_and_b32_dpp v19, v25, v7 row_newbcast:9 row_mask:0xf bank_mask:0xf
v_and_b32_dpp v20, v25, v8 row_newbcast:9 row_mask:0xf bank_mask:0xf
v_and_b32_dpp v21, v25, v9 row_newbcast:9 row_mask:0xf bank_mask:0xf
s_nop 1
v_mfma_f32_16x16x32_bf16 v[10:13], v[52:55], v[18:21], v[10:13]
s_waitcnt vmcnt(5)
buffer_load_dwordx4 v[76:79], v1, s[36:39], s57 offen offset:3072 nt
s_mov_b64 exec, 1
v_mov_b32 v43, 0
v_mov_b32 v44, 1
ds_add_u32 v43, v44 offset:412
s_mov_b64 exec, -1
s_waitcnt vmcnt(5)
v_and_b32_dpp v14, v25, v6 row_newbcast:10 row_mask:0xf bank_mask:0xf
v_and_b32_dpp v15, v25, v7 row_newbcast:10 row_mask:0xf bank_mask:0xf
v_and_b32_dpp v16, v25, v8 row_newbcast:10 row_mask:0xf bank_mask:0xf
v_and_b32_dpp v17, v25, v9 row_newbcast:10 row_mask:0xf bank_mask:0xf
s_nop 1
v_mfma_f32_16x16x32_bf16 v[10:13], v[56:59], v[14:17], v[10:13]
s_waitcnt vmcnt(4)
v_and_b32_dpp v18, v25, v6 row_newbcast:11 row_mask:0xf bank_mask:0xf
v_and_b32_dpp v19, v25, v7 row_newbcast:11 row_mask:0xf bank_mask:0xf
v_and_b32_dpp v20, v25, v8 row_newbcast:11 row_mask:0xf bank_mask:0xf
v_and_b32_dpp v21, v25, v9 row_newbcast:11 row_mask:0xf bank_mask:0xf
s_nop 1
v_mfma_f32_16x16x32_bf16 v[10:13], v[60:63], v[18:21], v[10:13]
s_waitcnt vmcnt(3)
v_and_b32_dpp v14, v25, v6 row_newbcast:12 row_mask:0xf bank_mask:0xf
v_and_b32_dpp v15, v25, v7 row_newbcast:12 row_mask:0xf bank_mask:0xf
v_and_b32_dpp v16, v25, v8 row_newbcast:12 row_mask:0xf bank_mask:0xf
v_and_b32_dpp v17, v25, v9 row_newbcast:12 row_mask:0xf bank_mask:0xf
s_nop 1
v_mfma_f32_16x16x32_bf16 v[10:13], v[64:67], v[14:17], v[10:13]
s_waitcnt vmcnt(2)
v_and_b32_dpp v18, v25, v6 row_newbcast:13 row_mask:0xf bank_mask:0xf
v_and_b32_dpp v19, v25, v7 row_newbcast:13 row_mask:0xf bank_mask:0xf
v_and_b32_dpp v20, v25, v8 row_newbcast:13 row_mask:0xf bank_mask:0xf
v_and_b32_dpp v21, v25, v9 row_newbcast:13 row_mask:0xf bank_mask:0xf
s_nop 1
v_mfma_f32_16x16x32_bf16 v[10:13], v[68:71], v[18:21], v[10:13]
s_waitcnt vmcnt(1)
v_and_b32_dpp v14, v25, v6 row_newbcast:14 row_mask:0xf bank_mask:0xf
v_and_b32_dpp v15, v25, v7 row_newbcast:14 row_mask:0xf bank_mask:0xf
v_and_b32_dpp v16, v25, v8 row_newbcast:14 row_mask:0xf bank_mask:0xf
v_and_b32_dpp v17, v25, v9 row_newbcast:14 row_mask:0xf bank_mask:0xf
s_nop 1
v_mfma_f32_16x16x32_bf16 v[10:13], v[72:75], v[14:17], v[10:13]
s_waitcnt vmcnt(0)
v_and_b32_dpp v18, v25, v6 row_newbcast:15 row_mask:0xf bank_mask:0xf
v_and_b32_dpp v19, v25, v7 row_newbcast:15 row_mask:0xf bank_mask:0xf
v_and_b32_dpp v20, v25, v8 row_newbcast:15 row_mask:0xf bank_mask:0xf
v_and_b32_dpp v21, v25, v9 row_newbcast:15 row_mask:0xf bank_mask:0xf
s_nop 1
v_mfma_f32_16x16x32_bf16 v[10:13], v[76:79], v[18:21], v[10:13]
v_mov_b32 v26, 0
v_mov_b32 v27, 1
s_mov_b32 exec_lo, 0x00ff00ff
s_mov_b32 exec_hi, 0x00ff00ff
s_nop 4
ds_write_b32 v34, v10 offset:512
ds_write_b32 v34, v11 offset:544
ds_write_b32 v34, v12 offset:576
ds_write_b32 v34, v13 offset:608
s_mov_b64 exec, 1
ds_add_rtn_u32 v27, v26, v27 offset:384
s_waitcnt lgkmcnt(0)
v_readfirstlane_b32 s56, v27
s_mov_b64 exec, 0xffff
s_cmp_lg_u32 s56, 3
s_cbranch_scc1 L_notlast_5
ds_read_b128 v[48:51], v35 offset:512
ds_read_b128 v[52:55], v35 offset:528
ds_read_b128 v[56:59], v35 offset:1024
ds_read_b128 v[60:63], v35 offset:1040
ds_read_b128 v[64:67], v35 offset:1536
ds_read_b128 v[68:71], v35 offset:1552
ds_read_b128 v[72:75], v35 offset:2048
ds_read_b128 v[76:79], v35 offset:2064
s_waitcnt lgkmcnt(4)
v_pk_add_f32 v[48:49], v[48:49], v[56:57]
v_pk_add_f32 v[50:51], v[50:51], v[58:59]
v_pk_add_f32 v[52:53], v[52:53], v[60:61]
v_pk_add_f32 v[54:55], v[54:55], v[62:63]
s_waitcnt lgkmcnt(0)
v_pk_add_f32 v[64:65], v[64:65], v[72:73]
v_pk_add_f32 v[66:67], v[66:67], v[74:75]
v_pk_add_f32 v[68:69], v[68:69], v[76:77]
v_pk_add_f32 v[70:71], v[70:71], v[78:79]
v_pk_add_f32 v[48:49], v[48:49], v[64:65]
v_pk_add_f32 v[50:51], v[50:51], v[66:67]
v_pk_add_f32 v[52:53], v[52:53], v[68:69]
v_pk_add_f32 v[54:55], v[54:55], v[70:71]
v_cvt_pk_bf16_f32 v48, v48, v49
v_cvt_pk_bf16_f32 v49, v50, v51
v_cvt_pk_bf16_f32 v50, v52, v53
v_cvt_pk_bf16_f32 v51, v54, v55
s_cmp_eq_u32 s67, 0
s_cbranch_scc1 L_wt_6
buffer_store_dwordx4 v[48:51], v36, s[40:43], s66 offen
s_branch L_wte_7
L_wt_6:
buffer_store_dwordx4 v[48:51], v36, s[40:43], s66 offen sc1
L_wte_7:
L_notlast_5:
s_endpgm
L_aux:
s_load_dword s30, s[28:29], 0
s_and_b32 s54, s49, 3
s_lshl_b32 s50, s48, 2
s_add_u32 s50, s50, s54
s_lshr_b32 s51, s49, 2
s_lshr_b32 s52, s51, 2
s_and_b32 s53, s51, 3
s_sub_u32 s58, s3, 4
s_cmp_lg_u32 s58, 2
s_cbranch_scc1 L_zc_8
v_mov_b32 v8, 0
v_mov_b32 v9, 0
v_mov_b32 v10, 0
v_mov_b32 v11, 0
s_nop 0
s_mov_b64 exec, 1
ds_write_b128 v8, v[8:11] offset:384
ds_write_b128 v8, v[8:11] offset:400
ds_write_b128 v8, v[8:11] offset:416
s_mov_b64 exec, -1
s_waitcnt lgkmcnt(0)
L_zc_8:
s_barrier
s_mov_b32 s40, s28
s_mov_b32 s41, s29
s_mov_b32 s42, 1179648
s_mov_b32 s43, 0x20000
v_and_b32 v2, 15, v0
v_lshrrev_b32 v3, 4, v0
v_mov_b32 v4, 0xfffffc00
s_mul_i32 s59, s48, 6
s_add_u32 s59, s59, s49
s_sub_u32 s59, s59, 24
s_cmp_lt_u32 s49, 24
s_cselect_b32 s59, 0xff, s59
s_cmp_ge_u32 s49, 30
s_cselect_b32 s59, 0xff, s59
s_cmp_ge_u32 s59, 43
s_cselect_b32 s59, 0xff, s59
s_cmp_eq_u32 s58, 1
s_cbranch_scc1 L_a1_9
s_cmp_eq_u32 s58, 2
s_cbranch_scc1 L_a2_10
s_cmp_eq_u32 s58, 3
s_cbranch_scc1 L_a3_11
s_cmp_ge_u32 s49, 24
s_cbranch_scc1 L_a3_11
s_lshr_b32 s64, s49, 2
s_and_b32 s65, s49, 3
s_mov_b32 s36, s20
s_mov_b32 s37, s21
s_mov_b32 s38, 2048
s_mov_b32 s39, 0x20000
v_and_b32 v5, 1, v3
v_lshlrev_b32 v8, 10, v5
v_lshlrev_b32 v9, 4, v2
v_add_u32 v8, v8, v9
s_lshl_b32 s55, s65, 8
buffer_load_dwordx4 v[12:15], v8, s[36:39], s55 offen
v_lshlrev_b32 v8, 8, v5
v_add_u32 v8, v8, v9
v_and_b32 v10, 1, v2
v_lshlrev_b32 v10, 8, v10
v_lshlrev_b32 v11, 4, v3
v_add_u32 v10, v10, v11
v_lshlrev_b32 v11, 3, v3
v_lshrrev_b32 v16, 2, v2
v_add_u32 v11, v11, v16
v_lshlrev_b32 v11, 7, v11
v_and_b32 v16, 3, v2
v_lshlrev_b32 v16, 3, v16
v_add_u32 v11, v11, v16
s_waitcnt vmcnt(0)
v_lshlrev_b32 v20, 16, v12
v_and_b32 v21, 0xffff0000, v12
v_lshlrev_b32 v22, 16, v13
v_and_b32 v23, 0xffff0000, v13
v_lshlrev_b32 v24, 16, v14
v_and_b32 v25, 0xffff0000, v14
v_lshlrev_b32 v26, 16, v15
v_and_b32 v27, 0xffff0000, v15
v_mul_f32 v28, 0xbfb8aa3b, v20
v_mul_f32 v29, 0xbfb8aa3b, v21
v_mul_f32 v30, 0xbfb8aa3b, v22
v_mul_f32 v31, 0xbfb8aa3b, v23
v_mul_f32 v32, 0xbfb8aa3b, v24
v_mul_f32 v33, 0xbfb8aa3b, v25
v_mul_f32 v34, 0xbfb8aa3b, v26
v_mul_f32 v35, 0xbfb8aa3b, v27
v_exp_f32 v28, v28
v_exp_f32 v29, v29
v_exp_f32 v30, v30
v_exp_f32 v31, v31
v_exp_f32 v32, v32
v_exp_f32 v33, v33
v_exp_f32 v34, v34
v_exp_f32 v35, v35
s_nop 0
v_add_f32 v28, 1.0, v28
v_add_f32 v29, 1.0, v29
v_add_f32 v30, 1.0, v30
v_add_f32 v31, 1.0, v31
v_add_f32 v32, 1.0, v32
v_add_f32 v33, 1.0, v33
v_add_f32 v34, 1.0, v34
v_add_f32 v35, 1.0, v35
v_rcp_f32 v28, v28
v_rcp_f32 v29, v29
v_rcp_f32 v30, v30
v_rcp_f32 v31, v31
v_rcp_f32 v32, v32
v_rcp_f32 v33, v33
v_rcp_f32 v34, v34
v_rcp_f32 v35, v35
s_nop 0
v_mul_f32 v20, v20, v28
v_mul_f32 v21, v21, v29
v_mul_f32 v22, v22, v30
v_mul_f32 v23, v23, v31
v_mul_f32 v24, v24, v32
v_mul_f32 v25, v25, v33
v_mul_f32 v26, v26, v34
v_mul_f32 v27, v27, v35
v_cvt_pk_bf16_f32 v12, v20, v21
v_cvt_pk_bf16_f32 v13, v22, v23
v_cvt_pk_bf16_f32 v14, v24, v25
v_cvt_pk_bf16_f32 v15, v26, v27
ds_write_b128 v8, v[12:15] offset:8960
s_waitcnt lgkmcnt(0)
s_add_u32 s31, s30, 1
s_and_b32 s31, s31, 1023
v_mov_b32 v1, s31
ds_read_b128 v[40:43], v10 offset:8960
ds_read_b128 v[44:47], v10 offset:9024
ds_read_b128 v[48:51], v10 offset:9088
ds_read_b128 v[52:55], v10 offset:9152
s_waitcnt lgkmcnt(0)
s_mov_b32 s70, 0
v_mov_b32 v12, 0
L_lw_13:
ds_read_b32 v13, v12 offset:388
s_waitcnt lgkmcnt(0)
v_readfirstlane_b32 s47, v13
s_add_u32 s70, s70, 1
s_cmp_gt_u32 s70, 1600004
s_cbranch_scc1 L_lwd_14
s_cmp_lt_u32 s47, 4
s_cbranch_scc1 L_lw_13
L_lwd_14:
ds_read_b64_tr_b16 v[64:65], v11 offset:20480
ds_read_b64_tr_b16 v[66:67], v11 offset:20992
ds_read_b64_tr_b16 v[68:69], v11 offset:24576
ds_read_b64_tr_b16 v[70:71], v11 offset:25088
ds_read_b64_tr_b16 v[72:73], v11 offset:28672
ds_read_b64_tr_b16 v[74:75], v11 offset:29184
ds_read_b64_tr_b16 v[76:77], v11 offset:32768
ds_read_b64_tr_b16 v[78:79], v11 offset:33280
s_waitcnt lgkmcnt(0)
v_mfma_f32_16x16x32_bf16 v[16:19], v[64:67], v[40:43], 0
v_mfma_f32_16x16x32_bf16 v[16:19], v[68:71], v[44:47], v[16:19]
v_mfma_f32_16x16x32_bf16 v[16:19], v[72:75], v[48:51], v[16:19]
v_mfma_f32_16x16x32_bf16 v[16:19], v[76:79], v[52:55], v[16:19]
ds_read_b64_tr_b16 v[80:81], v11 offset:20512
ds_read_b64_tr_b16 v[82:83], v11 offset:21024
ds_read_b64_tr_b16 v[84:85], v11 offset:24608
ds_read_b64_tr_b16 v[86:87], v11 offset:25120
ds_read_b64_tr_b16 v[88:89], v11 offset:28704
ds_read_b64_tr_b16 v[90:91], v11 offset:29216
ds_read_b64_tr_b16 v[92:93], v11 offset:32800
ds_read_b64_tr_b16 v[94:95], v11 offset:33312
s_waitcnt lgkmcnt(0)
v_mfma_f32_16x16x32_bf16 v[20:23], v[80:83], v[40:43], 0
v_mfma_f32_16x16x32_bf16 v[20:23], v[84:87], v[44:47], v[20:23]
v_mfma_f32_16x16x32_bf16 v[20:23], v[88:91], v[48:51], v[20:23]
v_mfma_f32_16x16x32_bf16 v[20:23], v[92:95], v[52:55], v[20:23]
ds_read_b64_tr_b16 v[96:97], v11 offset:20544
ds_read_b64_tr_b16 v[98:99], v11 offset:21056
ds_read_b64_tr_b16 v[100:101], v11 offset:24640
ds_read_b64_tr_b16 v[102:103], v11 offset:25152
ds_read_b64_tr_b16 v[104:105], v11 offset:28736
ds_read_b64_tr_b16 v[106:107], v11 offset:29248
ds_read_b64_tr_b16 v[108:109], v11 offset:32832
ds_read_b64_tr_b16 v[110:111], v11 offset:33344
s_waitcnt lgkmcnt(0)
v_mfma_f32_16x16x32_bf16 v[24:27], v[96:99], v[40:43], 0
v_mfma_f32_16x16x32_bf16 v[24:27], v[100:103], v[44:47], v[24:27]
v_mfma_f32_16x16x32_bf16 v[24:27], v[104:107], v[48:51], v[24:27]
v_mfma_f32_16x16x32_bf16 v[24:27], v[108:111], v[52:55], v[24:27]
ds_read_b64_tr_b16 v[112:113], v11 offset:20576
ds_read_b64_tr_b16 v[114:115], v11 offset:21088
ds_read_b64_tr_b16 v[116:117], v11 offset:24672
ds_read_b64_tr_b16 v[118:119], v11 offset:25184
ds_read_b64_tr_b16 v[120:121], v11 offset:28768
ds_read_b64_tr_b16 v[122:123], v11 offset:29280
ds_read_b64_tr_b16 v[124:125], v11 offset:32864
ds_read_b64_tr_b16 v[126:127], v11 offset:33376
s_waitcnt lgkmcnt(0)
v_mfma_f32_16x16x32_bf16 v[28:31], v[112:115], v[40:43], 0
v_mfma_f32_16x16x32_bf16 v[28:31], v[116:119], v[44:47], v[28:31]
v_mfma_f32_16x16x32_bf16 v[28:31], v[120:123], v[48:51], v[28:31]
v_mfma_f32_16x16x32_bf16 v[28:31], v[124:127], v[52:55], v[28:31]
s_lshl_b32 s54, s64, 3
s_add_u32 s54, s54, s48
s_lshl_b32 s66, s54, 11
s_add_u32 s66, s66, 4096
s_lshl_b32 s55, s65, 9
s_add_u32 s54, s66, s55
v_lshlrev_b32 v8, 6, v2
v_lshlrev_b32 v9, 4, v3
v_add_u32 v8, v8, v9
s_nop 4
v_add_u32 v16, 0x200, v16
v_and_or_b32 v16, v16, v4, v1
v_add_u32 v17, 0x200, v17
v_and_or_b32 v17, v17, v4, v1
v_add_u32 v18, 0x200, v18
v_and_or_b32 v18, v18, v4, v1
v_add_u32 v19, 0x200, v19
v_and_or_b32 v19, v19, v4, v1
v_add_u32 v20, 0x200, v20
v_and_or_b32 v20, v20, v4, v1
v_add_u32 v21, 0x200, v21
v_and_or_b32 v21, v21, v4, v1
v_add_u32 v22, 0x200, v22
v_and_or_b32 v22, v22, v4, v1
v_add_u32 v23, 0x200, v23
v_and_or_b32 v23, v23, v4, v1
v_add_u32 v24, 0x200, v24
v_and_or_b32 v24, v24, v4, v1
v_add_u32 v25, 0x200, v25
v_and_or_b32 v25, v25, v4, v1
v_add_u32 v26, 0x200, v26
v_and_or_b32 v26, v26, v4, v1
v_add_u32 v27, 0x200, v27
v_and_or_b32 v27, v27, v4, v1
v_add_u32 v28, 0x200, v28
v_and_or_b32 v28, v28, v4, v1
v_add_u32 v29, 0x200, v29
v_and_or_b32 v29, v29, v4, v1
v_add_u32 v30, 0x200, v30
v_and_or_b32 v30, v30, v4, v1
v_add_u32 v31, 0x200, v31
v_and_or_b32 v31, v31, v4, v1
s_mov_b32 exec_lo, 0x00030003
s_mov_b32 exec_hi, 0x00030003
buffer_store_dwordx4 v[16:19], v8, s[40:43], s54 offen offset:0 sc1
buffer_store_dwordx4 v[20:23], v8, s[40:43], s54 offen offset:128 sc1
buffer_store_dwordx4 v[24:27], v8, s[40:43], s54 offen offset:256 sc1
buffer_store_dwordx4 v[28:31], v8, s[40:43], s54 offen offset:384 sc1
s_mov_b64 exec, -1
s_branch L_aux_b1_12
L_a1_9:
s_mov_b32 s36, s4
s_mov_b32 s37, s5
s_mov_b32 s38, 2048
s_mov_b32 s39, 0x20000
v_lshlrev_b32 v8, 4, v0
buffer_load_dwordx4 v[12:15], v8, s[36:39], 0 offen
buffer_load_dwordx4 v[16:19], v8, s[36:39], 0 offen offset:1024
v_lshrrev_b32 v5, 2, v0
v_and_b32 v5, 1, v5
v_lshrrev_b32 v6, 3, v0
v_and_b32 v6, 3, v6
v_lshlrev_b32 v6, 4, v6
v_and_b32 v7, 3, v0
v_lshlrev_b32 v7, 2, v7
v_add_u32 v6, v6, v7
v_lshlrev_b32 v7, 10, v5
v_lshlrev_b32 v9, 1, v6
v_add_u32 v9, v9, v7
s_lshl_b32 s55, s51, 7
buffer_load_dwordx2 v[20:21], v9, s[36:39], s55 offen
v_lshlrev_b32 v11, 3, v3
v_lshrrev_b32 v22, 2, v2
v_add_u32 v11, v11, v22
v_lshlrev_b32 v11, 8, v11
v_and_b32 v22, 3, v2
v_lshlrev_b32 v22, 3, v22
v_add_u32 v11, v11, v22
s_waitcnt vmcnt(0)
v_lshlrev_b32 v24, 16, v12
v_and_b32 v25, 0xffff0000, v12
v_lshlrev_b32 v26, 16, v13
v_and_b32 v27, 0xffff0000, v13
v_lshlrev_b32 v28, 16, v14
v_and_b32 v29, 0xffff0000, v14
v_lshlrev_b32 v30, 16, v15
v_and_b32 v31, 0xffff0000, v15
v_lshlrev_b32 v32, 16, v16
v_and_b32 v33, 0xffff0000, v16
v_lshlrev_b32 v34, 16, v17
v_and_b32 v35, 0xffff0000, v17
v_lshlrev_b32 v36, 16, v18
v_and_b32 v37, 0xffff0000, v18
v_lshlrev_b32 v38, 16, v19
v_and_b32 v39, 0xffff0000, v19
v_add_f32 v40, v24, v25
v_add_f32 v40, v40, v26
v_add_f32 v40, v40, v27
v_add_f32 v40, v40, v28
v_add_f32 v40, v40, v29
v_add_f32 v40, v40, v30
v_add_f32 v40, v40, v31
v_add_f32 v41, v32, v33
v_add_f32 v41, v41, v34
v_add_f32 v41, v41, v35
v_add_f32 v41, v41, v36
v_add_f32 v41, v41, v37
v_add_f32 v41, v41, v38
v_add_f32 v41, v41, v39
s_nop 1
v_add_f32_dpp v40, v40, v40 row_ror:8 row_mask:0xf bank_mask:0xf
v_add_f32_dpp v41, v41, v41 row_ror:8 row_mask:0xf bank_mask:0xf
s_nop 1
v_add_f32_dpp v40, v40, v40 row_ror:4 row_mask:0xf bank_mask:0xf
v_add_f32_dpp v41, v41, v41 row_ror:4 row_mask:0xf bank_mask:0xf
s_nop 1
v_add_f32_dpp v40, v40, v40 row_ror:2 row_mask:0xf bank_mask:0xf
v_add_f32_dpp v41, v41, v41 row_ror:2 row_mask:0xf bank_mask:0xf
s_nop 1
v_add_f32_dpp v40, v40, v40 row_ror:1 row_mask:0xf bank_mask:0xf
v_add_f32_dpp v41, v41, v41 row_ror:1 row_mask:0xf bank_mask:0xf
s_nop 0
v_mov_b32 v44, v40
v_mov_b32 v45, v41
s_nop 1
v_permlane16_swap_b32 v40, v44
v_permlane16_swap_b32 v41, v45
s_nop 1
v_add_f32 v40, v40, v44
v_add_f32 v41, v41, v45
s_nop 0
v_mov_b32 v44, v40
v_mov_b32 v45, v41
s_nop 1
v_permlane32_swap_b32 v40, v44
v_permlane32_swap_b32 v41, v45
s_nop 1
v_add_f32 v40, v40, v44
v_add_f32 v41, v41, v45
v_mul_f32 v40, 0x3b000000, v40
v_mul_f32 v41, 0x3b000000, v41
v_sub_f32 v24, v24, v40
v_sub_f32 v25, v25, v40
v_sub_f32 v26, v26, v40
v_sub_f32 v27, v27, v40
v_sub_f32 v28, v28, v40
v_sub_f32 v29, v29, v40
v_sub_f32 v30, v30, v40
v_sub_f32 v31, v31, v40
v_mul_f32 v42, v24, v24
v_fmac_f32 v42, v25, v25
v_fmac_f32 v42, v26, v26
v_fmac_f32 v42, v27, v27
v_fmac_f32 v42, v28, v28
v_fmac_f32 v42, v29, v29
v_fmac_f32 v42, v30, v30
v_fmac_f32 v42, v31, v31
v_sub_f32 v32, v32, v41
v_sub_f32 v33, v33, v41
v_sub_f32 v34, v34, v41
v_sub_f32 v35, v35, v41
v_sub_f32 v36, v36, v41
v_sub_f32 v37, v37, v41
v_sub_f32 v38, v38, v41
v_sub_f32 v39, v39, v41
v_mul_f32 v43, v32, v32
v_fmac_f32 v43, v33, v33
v_fmac_f32 v43, v34, v34
v_fmac_f32 v43, v35, v35
v_fmac_f32 v43, v36, v36
v_fmac_f32 v43, v37, v37
v_fmac_f32 v43, v38, v38
v_fmac_f32 v43, v39, v39
s_nop 1
v_add_f32_dpp v42, v42, v42 row_ror:8 row_mask:0xf bank_mask:0xf
v_add_f32_dpp v43, v43, v43 row_ror:8 row_mask:0xf bank_mask:0xf
s_nop 1
v_add_f32_dpp v42, v42, v42 row_ror:4 row_mask:0xf bank_mask:0xf
v_add_f32_dpp v43, v43, v43 row_ror:4 row_mask:0xf bank_mask:0xf
s_nop 1
v_add_f32_dpp v42, v42, v42 row_ror:2 row_mask:0xf bank_mask:0xf
v_add_f32_dpp v43, v43, v43 row_ror:2 row_mask:0xf bank_mask:0xf
s_nop 1
v_add_f32_dpp v42, v42, v42 row_ror:1 row_mask:0xf bank_mask:0xf
v_add_f32_dpp v43, v43, v43 row_ror:1 row_mask:0xf bank_mask:0xf
s_nop 0
v_mov_b32 v44, v42
v_mov_b32 v45, v43
s_nop 1
v_permlane16_swap_b32 v42, v44
v_permlane16_swap_b32 v43, v45
s_nop 1
v_add_f32 v42, v42, v44
v_add_f32 v43, v43, v45
s_nop 0
v_mov_b32 v44, v42
v_mov_b32 v45, v43
s_nop 1
v_permlane32_swap_b32 v42, v44
v_permlane32_swap_b32 v43, v45
s_nop 1
v_add_f32 v42, v42, v44
v_add_f32 v43, v43, v45
v_mov_b32 v44, 0x3727c5ac
v_fmac_f32 v44, 0x3b000000, v42
v_rsq_f32 v42, v44
s_nop 0
v_mov_b32 v44, 0x3727c5ac
v_fmac_f32 v44, 0x3b000000, v43
v_rsq_f32 v43, v44
s_nop 0
v_cmp_eq_u32 vcc, 1, v5
s_nop 1
v_cndmask_b32 v40, v40, v41, vcc
v_cndmask_b32 v42, v42, v43, vcc
v_lshlrev_b32 v24, 16, v20
v_and_b32 v25, 0xffff0000, v20
v_lshlrev_b32 v26, 16, v21
v_and_b32 v27, 0xffff0000, v21
v_sub_f32 v24, v24, v40
v_mul_f32 v24, v24, v42
v_sub_f32 v25, v25, v40
v_mul_f32 v25, v25, v42
v_sub_f32 v26, v26, v40
v_mul_f32 v26, v26, v42
v_sub_f32 v27, v27, v40
v_mul_f32 v27, v27, v42
s_waitcnt lgkmcnt(0)
s_add_u32 s31, s30, 1
s_and_b32 s31, s31, 1023
v_mov_b32 v1, s31
s_mov_b32 s70, 0
v_mov_b32 v12, 0
L_lw_15:
ds_read_b32 v13, v12 offset:392
s_waitcnt lgkmcnt(0)
v_readfirstlane_b32 s47, v13
s_add_u32 s70, s70, 1
s_cmp_gt_u32 s70, 1600004
s_cbranch_scc1 L_lwd_16
s_cmp_lt_u32 s47, 4
s_cbranch_scc1 L_lw_15
L_lwd_16:
ds_read_b64_tr_b16 v[64:65], v11 offset:36864
ds_read_b64_tr_b16 v[66:67], v11 offset:37888
ds_read_b64_tr_b16 v[68:69], v11 offset:45056
ds_read_b64_tr_b16 v[70:71], v11 offset:46080
ds_read_b64_tr_b16 v[72:73], v11 offset:36896
ds_read_b64_tr_b16 v[74:75], v11 offset:37920
ds_read_b64_tr_b16 v[76:77], v11 offset:45088
ds_read_b64_tr_b16 v[78:79], v11 offset:46112
s_waitcnt lgkmcnt(0)
ds_read_b64_tr_b16 v[80:81], v11 offset:36928
ds_read_b64_tr_b16 v[82:83], v11 offset:37952
ds_read_b64_tr_b16 v[84:85], v11 offset:45120
ds_read_b64_tr_b16 v[86:87], v11 offset:46144
ds_read_b64_tr_b16 v[88:89], v11 offset:36960
ds_read_b64_tr_b16 v[90:91], v11 offset:37984
ds_read_b64_tr_b16 v[92:93], v11 offset:45152
ds_read_b64_tr_b16 v[94:95], v11 offset:46176
s_waitcnt lgkmcnt(0)
ds_read_b64_tr_b16 v[96:97], v11 offset:36992
ds_read_b64_tr_b16 v[98:99], v11 offset:38016
ds_read_b64_tr_b16 v[100:101], v11 offset:45184
ds_read_b64_tr_b16 v[102:103], v11 offset:46208
ds_read_b64_tr_b16 v[104:105], v11 offset:37024
ds_read_b64_tr_b16 v[106:107], v11 offset:38048
ds_read_b64_tr_b16 v[108:109], v11 offset:45216
ds_read_b64_tr_b16 v[110:111], v11 offset:46240
s_waitcnt lgkmcnt(0)
ds_read_b64_tr_b16 v[112:113], v11 offset:37056
ds_read_b64_tr_b16 v[114:115], v11 offset:38080
ds_read_b64_tr_b16 v[116:117], v11 offset:45248
ds_read_b64_tr_b16 v[118:119], v11 offset:46272
ds_read_b64_tr_b16 v[120:121], v11 offset:37088
ds_read_b64_tr_b16 v[122:123], v11 offset:38112
ds_read_b64_tr_b16 v[124:125], v11 offset:45280
ds_read_b64_tr_b16 v[126:127], v11 offset:46304
s_waitcnt lgkmcnt(0)
s_lshl_b32 s54, s51, 11
s_add_u32 s54, s54, 4096
s_add_u32 s55, s54, 16384
v_lshlrev_b32 v9, 4, v0
v_and_b32 v10, 31, v0
v_lshlrev_b32 v10, 7, v10
s_lshl_b32 s56, s48, 12
s_add_u32 s56, s56, 163840
s_mul_i32 s57, s31, 0x00400401
v_mov_b32 v7, s57
s_mov_b32 s70, 0
L_p_saca_18:
buffer_load_dwordx4 v[28:31], v9, s[40:43], s54 offen sc1
buffer_load_dwordx4 v[32:35], v9, s[40:43], s54 offen offset:1024 sc1
buffer_load_dwordx4 v[36:39], v9, s[40:43], s55 offen sc1
buffer_load_dwordx4 v[40:43], v9, s[40:43], s55 offen offset:1024 sc1
buffer_load_dwordx4 v[52:55], v10, s[40:43], s56 offen sc1
s_waitcnt vmcnt(0)
v_xor_b32 v28, v28, v1
v_xor_b32 v29, v29, v1
v_xor_b32 v30, v30, v1
v_xor_b32 v31, v31, v1
v_xor_b32 v32, v32, v1
v_xor_b32 v33, v33, v1
v_xor_b32 v34, v34, v1
v_xor_b32 v35, v35, v1
v_xor_b32 v36, v36, v1
v_xor_b32 v37, v37, v1
v_xor_b32 v38, v38, v1
v_xor_b32 v39, v39, v1
v_xor_b32 v40, v40, v1
v_xor_b32 v41, v41, v1
v_xor_b32 v42, v42, v1
v_xor_b32 v43, v43, v1
v_or_b32 v12, v28, v29
v_or3_b32 v12, v12, v30, v31
v_or3_b32 v12, v12, v32, v33
v_or3_b32 v12, v12, v34, v35
v_or3_b32 v12, v12, v36, v37
v_or3_b32 v12, v12, v38, v39
v_or3_b32 v12, v12, v40, v41
v_or3_b32 v12, v12, v42, v43
v_and_b32 v12, 1023, v12
v_cmp_ne_u32 vcc, 0, v12
v_xor_b32 v13, v52, v7
v_sub_u32 v56, v53, v7
v_lshrrev_b32 v14, 4, v56
v_or3_b32 v12, v12, v13, v14
v_cmp_ne_u32 vcc, 0, v12
s_add_u32 s70, s70, 1
s_cmp_gt_u32 s70, 400000
s_cbranch_scc1 L_p_saca_done_17
s_cbranch_vccnz L_p_saca_18
L_p_saca_done_17:
s_getreg_b32 s64, hwreg(HW_REG_XCC_ID, 0, 4)
v_cmp_ne_u32 vcc, s64, v56
s_nop 4
s_cmp_eq_u64 vcc, 0
s_cselect_b32 s69, 1, 0
v_mov_b32 v12, 0
v_mov_b32 v13, s69
ds_write_b32 v12, v13 offset:404
v_add_f32 v28, v28, v32
v_add_f32 v36, v36, v40
v_add_f32 v29, v29, v33
v_add_f32 v37, v37, v41
v_add_f32 v30, v30, v34
v_add_f32 v38, v38, v42
v_add_f32 v31, v31, v35
v_add_f32 v39, v39, v43
s_nop 0
v_mov_b32 v44, v28
v_mov_b32 v45, v29
v_mov_b32 v46, v30
v_mov_b32 v47, v31
v_mov_b32 v48, v36
v_mov_b32 v49, v37
v_mov_b32 v50, v38
v_mov_b32 v51, v39
s_nop 1
v_permlane32_swap_b32 v28, v44
v_permlane32_swap_b32 v29, v45
v_permlane32_swap_b32 v30, v46
v_permlane32_swap_b32 v31, v47
v_permlane32_swap_b32 v36, v48
v_permlane32_swap_b32 v37, v49
v_permlane32_swap_b32 v38, v50
v_permlane32_swap_b32 v39, v51
s_nop 1
v_add_f32 v28, v28, v44
v_add_f32 v29, v29, v45
v_add_f32 v30, v30, v46
v_add_f32 v31, v31, v47
v_add_f32 v36, v36, v48
v_add_f32 v37, v37, v49
v_add_f32 v38, v38, v50
v_add_f32 v39, v39, v51
v_cvt_pk_bf16_f32 v44, v28, v29
v_cvt_pk_bf16_f32 v45, v30, v31
v_cvt_pk_bf16_f32 v46, v36, v37
v_cvt_pk_bf16_f32 v47, v38, v39
v_lshlrev_b32 v28, 16, v44
v_lshlrev_b32 v36, 16, v46
v_and_b32 v29, 0xffff0000, v44
v_and_b32 v37, 0xffff0000, v46
v_lshlrev_b32 v30, 16, v45
v_lshlrev_b32 v38, 16, v47
v_and_b32 v31, 0xffff0000, v45
v_and_b32 v39, 0xffff0000, v47
v_add_f32 v36, 1.0, v36
v_fma_f32 v24, v24, v36, v28
v_add_f32 v37, 1.0, v37
v_fma_f32 v25, v25, v37, v29
v_add_f32 v38, 1.0, v38
v_fma_f32 v26, v26, v38, v30
v_add_f32 v39, 1.0, v39
v_fma_f32 v27, v27, v39, v31
v_cvt_pk_bf16_f32 v24, v24, v25
v_cvt_pk_bf16_f32 v25, v26, v27
v_lshlrev_b32 v9, 7, v5
v_lshlrev_b32 v10, 1, v6
v_add_u32 v9, v9, v10
ds_write_b64 v9, v[24:25] offset:9472
v_and_b32 v10, 1, v2
v_lshlrev_b32 v10, 7, v10
v_lshlrev_b32 v12, 4, v3
v_add_u32 v10, v10, v12
s_waitcnt lgkmcnt(0)
ds_read_b128 v[24:27], v10 offset:9472
ds_read_b128 v[28:31], v10 offset:9536
s_waitcnt lgkmcnt(0)
v_mfma_f32_16x16x32_bf16 v[128:131], v[64:67], v[24:27], 0
v_mfma_f32_16x16x32_bf16 v[132:135], v[72:75], v[24:27], 0
v_mfma_f32_16x16x32_bf16 v[136:139], v[80:83], v[24:27], 0
v_mfma_f32_16x16x32_bf16 v[140:143], v[88:91], v[24:27], 0
v_mfma_f32_16x16x32_bf16 v[144:147], v[96:99], v[24:27], 0
v_mfma_f32_16x16x32_bf16 v[148:151], v[104:107], v[24:27], 0
v_mfma_f32_16x16x32_bf16 v[152:155], v[112:115], v[24:27], 0
v_mfma_f32_16x16x32_bf16 v[156:159], v[120:123], v[24:27], 0
v_mfma_f32_16x16x32_bf16 v[128:131], v[68:71], v[28:31], v[128:131]
v_mfma_f32_16x16x32_bf16 v[132:135], v[76:79], v[28:31], v[132:135]
v_mfma_f32_16x16x32_bf16 v[136:139], v[84:87], v[28:31], v[136:139]
v_mfma_f32_16x16x32_bf16 v[140:143], v[92:95], v[28:31], v[140:143]
v_mfma_f32_16x16x32_bf16 v[144:147], v[100:103], v[28:31], v[144:147]
v_mfma_f32_16x16x32_bf16 v[148:151], v[108:111], v[28:31], v[148:151]
v_mfma_f32_16x16x32_bf16 v[152:155], v[116:119], v[28:31], v[152:155]
v_mfma_f32_16x16x32_bf16 v[156:159], v[124:127], v[28:31], v[156:159]
s_lshl_b32 s54, s50, 13
s_lshl_b32 s55, s51, 9
s_add_u32 s66, s54, 196608
s_add_u32 s54, s66, s55
v_and_b32 v8, 1, v2
v_lshlrev_b32 v8, 12, v8
v_lshrrev_b32 v9, 1, v2
v_and_b32 v9, 1, v9
v_cmp_eq_u32 vcc, 1, v9
v_lshlrev_b32 v9, 6, v9
v_add_u32 v8, v8, v9
v_lshlrev_b32 v9, 4, v3
v_add_u32 v8, v8, v9
s_nop 1
v_cndmask_b32 v128, v128, v132, vcc
v_cndmask_b32 v129, v129, v133, vcc
v_cndmask_b32 v130, v130, v134, vcc
v_cndmask_b32 v131, v131, v135, vcc
v_add_u32 v128, 0x200, v128
v_and_or_b32 v128, v128, v4, v1
v_add_u32 v129, 0x200, v129
v_and_or_b32 v129, v129, v4, v1
v_add_u32 v130, 0x200, v130
v_and_or_b32 v130, v130, v4, v1
v_add_u32 v131, 0x200, v131
v_and_or_b32 v131, v131, v4, v1
v_cndmask_b32 v136, v136, v140, vcc
v_cndmask_b32 v137, v137, v141, vcc
v_cndmask_b32 v138, v138, v142, vcc
v_cndmask_b32 v139, v139, v143, vcc
v_add_u32 v136, 0x200, v136
v_and_or_b32 v136, v136, v4, v1
v_add_u32 v137, 0x200, v137
v_and_or_b32 v137, v137, v4, v1
v_add_u32 v138, 0x200, v138
v_and_or_b32 v138, v138, v4, v1
v_add_u32 v139, 0x200, v139
v_and_or_b32 v139, v139, v4, v1
v_cndmask_b32 v144, v144, v148, vcc
v_cndmask_b32 v145, v145, v149, vcc
v_cndmask_b32 v146, v146, v150, vcc
v_cndmask_b32 v147, v147, v151, vcc
v_add_u32 v144, 0x200, v144
v_and_or_b32 v144, v144, v4, v1
v_add_u32 v145, 0x200, v145
v_and_or_b32 v145, v145, v4, v1
v_add_u32 v146, 0x200, v146
v_and_or_b32 v146, v146, v4, v1
v_add_u32 v147, 0x200, v147
v_and_or_b32 v147, v147, v4, v1
v_cndmask_b32 v152, v152, v156, vcc
v_cndmask_b32 v153, v153, v157, vcc
v_cndmask_b32 v154, v154, v158, vcc
v_cndmask_b32 v155, v155, v159, vcc
v_add_u32 v152, 0x200, v152
v_and_or_b32 v152, v152, v4, v1
v_add_u32 v153, 0x200, v153
v_and_or_b32 v153, v153, v4, v1
v_add_u32 v154, 0x200, v154
v_and_or_b32 v154, v154, v4, v1
v_add_u32 v155, 0x200, v155
v_and_or_b32 v155, v155, v4, v1
s_mov_b32 exec_lo, 0x000f000f
s_mov_b32 exec_hi, 0x000f000f
s_cmp_eq_u32 s69, 0
s_cbranch_scc1 L_wt_19
buffer_store_dwordx4 v[128:131], v8, s[40:43], s54 offen offset:0
buffer_store_dwordx4 v[136:139], v8, s[40:43], s54 offen offset:128
buffer_store_dwordx4 v[144:147], v8, s[40:43], s54 offen offset:256
buffer_store_dwordx4 v[152:155], v8, s[40:43], s54 offen offset:384
s_branch L_wte_20
L_wt_19:
buffer_store_dwordx4 v[128:131], v8, s[40:43], s54 offen offset:0 sc1
buffer_store_dwordx4 v[136:139], v8, s[40:43], s54 offen offset:128 sc1
buffer_store_dwordx4 v[144:147], v8, s[40:43], s54 offen offset:256 sc1
buffer_store_dwordx4 v[152:155], v8, s[40:43], s54 offen offset:384 sc1
L_wte_20:
s_mov_b64 exec, -1
s_mov_b32 s70, 0
v_mov_b32 v12, 0
L_lw_21:
ds_read_b32 v13, v12 offset:416
s_waitcnt lgkmcnt(0)
v_readfirstlane_b32 s47, v13
s_add_u32 s70, s70, 1
s_cmp_gt_u32 s70, 1600004
s_cbranch_scc1 L_lwd_22
s_cmp_lt_u32 s47, 4
s_cbranch_scc1 L_lw_21
L_lwd_22:
v_lshlrev_b32 v8, 4, v0
s_lshl_b32 s55, s52, 12
s_add_u32 s54, s66, s55
s_mov_b32 s70, 0
L_p_q_24:
buffer_load_dwordx4 v[16:19], v8, s[40:43], s54 offen offset:0 sc1
buffer_load_dwordx4 v[20:23], v8, s[40:43], s54 offen offset:1024 sc1
buffer_load_dwordx4 v[24:27], v8, s[40:43], s54 offen offset:2048 sc1
buffer_load_dwordx4 v[28:31], v8, s[40:43], s54 offen offset:3072 sc1
s_waitcnt vmcnt(0)
v_xor_b32 v16, v16, v1
v_xor_b32 v17, v17, v1
v_xor_b32 v18, v18, v1
v_xor_b32 v19, v19, v1
v_xor_b32 v20, v20, v1
v_xor_b32 v21, v21, v1
v_xor_b32 v22, v22, v1
v_xor_b32 v23, v23, v1
v_xor_b32 v24, v24, v1
v_xor_b32 v25, v25, v1
v_xor_b32 v26, v26, v1
v_xor_b32 v27, v27, v1
v_xor_b32 v28, v28, v1
v_xor_b32 v29, v29, v1
v_xor_b32 v30, v30, v1
v_xor_b32 v31, v31, v1
v_or_b32 v12, v16, v17
v_or3_b32 v12, v12, v18, v19
v_or3_b32 v12, v12, v20, v21
v_or3_b32 v12, v12, v22, v23
v_or3_b32 v12, v12, v24, v25
v_or3_b32 v12, v12, v26, v27
v_or3_b32 v12, v12, v28, v29
v_or3_b32 v12, v12, v30, v31
v_and_b32 v12, 1023, v12
v_cmp_ne_u32 vcc, 0, v12
s_add_u32 s70, s70, 1
s_cmp_gt_u32 s70, 400000
s_cbranch_scc1 L_p_q_done_23
s_cbranch_vccnz L_p_q_24
L_p_q_done_23:
v_add_f32 v16, v16, v20
v_add_f32 v24, v24, v28
v_add_f32 v16, v16, v24
v_add_f32 v17, v17, v21
v_add_f32 v25, v25, v29
v_add_f32 v17, v17, v25
v_add_f32 v18, v18, v22
v_add_f32 v26, v26, v30
v_add_f32 v18, v18, v26
v_add_f32 v19, v19, v23
v_add_f32 v27, v27, v31
v_add_f32 v19, v19, v27
s_nop 0
v_mov_b32 v20, v16
v_mov_b32 v21, v17
v_mov_b32 v22, v18
v_mov_b32 v23, v19
s_nop 1
v_permlane32_swap_b32 v16, v20
v_permlane32_swap_b32 v17, v21
v_permlane32_swap_b32 v18, v22
v_permlane32_swap_b32 v19, v23
s_nop 1
v_add_f32 v16, v16, v20
v_add_f32 v17, v17, v21
v_add_f32 v18, v18, v22
v_add_f32 v19, v19, v23
v_cvt_pk_bf16_f32 v16, v16, v17
v_cvt_pk_bf16_f32 v17, v18, v19
v_and_b32 v9, 31, v0
v_lshlrev_b32 v9, 3, v9
ds_write_b64 v9, v[16:17] offset:0
s_branch L_aux_b1_12
L_a2_10:
s_waitcnt lgkmcnt(0)
s_add_u32 s31, s30, 1
s_and_b32 s31, s31, 1023
v_mov_b32 v1, s31
s_mul_i32 s55, s31, 0x00400401
s_getreg_b32 s64, hwreg(HW_REG_XCC_ID, 0, 4)
s_add_u32 s64, s64, s55
v_mov_b32 v8, s55
v_mov_b32 v9, s64
v_mov_b32 v10, s55
v_mov_b32 v11, s55
v_lshlrev_b32 v12, 4, v0
s_lshl_b32 s54, s48, 5
s_add_u32 s54, s54, s49
s_lshl_b32 s54, s54, 7
s_add_u32 s54, s54, 163840
s_mov_b64 exec, 0xff
buffer_store_dwordx4 v[8:11], v12, s[40:43], s54 offen sc1
s_mov_b64 exec, -1
s_branch L_aux_b1_12
L_a3_11:
s_waitcnt lgkmcnt(0)
s_add_u32 s31, s30, 1
s_and_b32 s31, s31, 1023
v_mov_b32 v1, s31
L_aux_b1_12:
s_waitcnt lgkmcnt(0)
s_barrier
s_cmp_lg_u32 s58, 2
s_cbranch_scc1 L_noinit_26
v_mov_b32 v8, 0
ds_read_b32 v8, v8 offset:404
v_lshlrev_b32 v12, 4, v0
s_waitcnt lgkmcnt(0)
v_readfirstlane_b32 s69, v8
v_mov_b32 v8, -1
v_mov_b32 v9, -1
v_mov_b32 v10, -1
v_mov_b32 v11, -1
s_lshl_b32 s54, s50, 3
s_add_u32 s54, s54, s51
s_lshl_b32 s54, s54, 8
s_add_u32 s54, s54, 458752
s_mov_b64 exec, 0xffff
s_cmp_eq_u32 s69, 0
s_cbranch_scc1 L_wt_27
buffer_store_dwordx4 v[8:11], v12, s[40:43], s54 offen
s_branch L_wte_28
L_wt_27:
buffer_store_dwordx4 v[8:11], v12, s[40:43], s54 offen sc1
L_wte_28:
s_mov_b64 exec, -1
L_noinit_26:
s_barrier
s_cmp_lg_u32 s58, 2
s_cbranch_scc1 L_noml_25
v_mov_b32 v8, 0
ds_read_b128 v[12:15], v8 offset:256
ds_read_b128 v[16:19], v8 offset:272
s_waitcnt lgkmcnt(0)
v_max3_f32 v20, v12, v14, v16
v_max_f32 v20, v20, v18
v_sub_f32 v12, v12, v20
v_exp_f32 v12, v12
v_sub_f32 v14, v14, v20
v_exp_f32 v14, v14
v_sub_f32 v16, v16, v20
v_exp_f32 v16, v16
v_sub_f32 v18, v18, v20
v_exp_f32 v18, v18
s_nop 0
v_mul_f32 v21, v12, v13
v_fmac_f32 v21, v14, v15
v_fmac_f32 v21, v16, v17
v_fmac_f32 v21, v18, v19
s_mul_i32 s55, s31, 0x00400401
v_mov_b32 v22, s55
s_getreg_b32 s64, hwreg(HW_REG_XCC_ID, 0, 4)
s_add_u32 s55, s55, s64
v_mov_b32 v23, s55
s_lshl_b32 s54, s50, 3
s_add_u32 s54, s54, s51
s_lshl_b32 s54, s54, 7
s_add_u32 s54, s54, 131072
v_lshlrev_b32 v8, 4, v0
s_waitcnt vmcnt(0)
s_mov_b64 exec, 0xff
s_cmp_eq_u32 s69, 0
s_cbranch_scc1 L_wt_29
buffer_store_dwordx4 v[20:23], v8, s[40:43], s54 offen
s_branch L_wte_30
L_wt_29:
buffer_store_dwordx4 v[20:23], v8, s[40:43], s54 offen sc1
L_wte_30:
s_mov_b64 exec, -1
L_noml_25:
s_cmp_lg_u32 s58, 0
s_cbranch_scc1 L_nofin_31
s_sub_u32 s55, s49, 8
s_and_b32 s54, s49, 3
s_cmp_lg_u32 s54, 0
s_cbranch_scc1 L_nofin_31
s_cmp_ge_u32 s55, 16
s_cbranch_scc1 L_nofin_31
s_lshr_b32 s64, s49, 2
s_lshl_b32 s54, s64, 3
s_add_u32 s54, s54, s48
s_lshl_b32 s66, s54, 11
s_add_u32 s66, s66, 4096
v_lshlrev_b32 v8, 4, v0
s_mov_b32 s70, 0
L_p_fin_33:
buffer_load_dwordx4 v[16:19], v8, s[40:43], s66 offen sc1
buffer_load_dwordx4 v[20:23], v8, s[40:43], s66 offen offset:1024 sc1
s_waitcnt vmcnt(0)
v_xor_b32 v16, v16, v1
v_xor_b32 v17, v17, v1
v_xor_b32 v18, v18, v1
v_xor_b32 v19, v19, v1
v_xor_b32 v20, v20, v1
v_xor_b32 v21, v21, v1
v_xor_b32 v22, v22, v1
v_xor_b32 v23, v23, v1
v_or_b32 v12, v16, v17
v_or3_b32 v12, v12, v18, v19
v_or3_b32 v12, v12, v20, v21
v_or3_b32 v12, v12, v22, v23
v_and_b32 v12, 1023, v12
v_cmp_ne_u32 vcc, 0, v12
s_add_u32 s70, s70, 1
s_cmp_gt_u32 s70, 400000
s_cbranch_scc1 L_p_fin_done_32
s_cbranch_vccnz L_p_fin_33
L_p_fin_done_32:
v_add_f32 v16, v16, v20
v_add_f32 v17, v17, v21
v_add_f32 v18, v18, v22
v_add_f32 v19, v19, v23
s_nop 0
v_mov_b32 v20, v16
v_mov_b32 v21, v17
v_mov_b32 v22, v18
v_mov_b32 v23, v19
s_nop 1
v_permlane32_swap_b32 v16, v20
v_permlane32_swap_b32 v17, v21
v_permlane32_swap_b32 v18, v22
v_permlane32_swap_b32 v19, v23
s_nop 1
v_add_f32 v16, v16, v20
v_add_f32 v17, v17, v21
v_add_f32 v18, v18, v22
v_add_f32 v19, v19, v23
v_cvt_pk_bf16_f32 v20, v16, v17
v_cvt_pk_bf16_f32 v21, v18, v19
v_lshlrev_b32 v16, 16, v20
v_and_b32 v17, 0xffff0000, v20
v_lshlrev_b32 v18, 16, v21
v_and_b32 v19, 0xffff0000, v21
v_and_or_b32 v16, v16, v4, v1
v_and_or_b32 v17, v17, v4, v1
v_and_or_b32 v18, v18, v4, v1
v_and_or_b32 v19, v19, v4, v1
v_lshrrev_b32 v8, 3, v0
v_and_b32 v8, 3, v8
v_lshlrev_b32 v8, 6, v8
v_lshrrev_b32 v9, 2, v0
v_and_b32 v9, 1, v9
v_lshlrev_b32 v9, 11, v9
v_add_u32 v8, v8, v9
v_and_b32 v9, 3, v0
v_lshlrev_b32 v9, 4, v9
v_add_u32 v8, v8, v9
s_sub_u32 s54, s64, 2
s_lshl_b32 s54, s54, 12
s_lshl_b32 s55, s48, 8
s_add_u32 s54, s54, s55
s_add_u32 s54, s54, 102400
s_mov_b32 exec_hi, 0
buffer_store_dwordx4 v[16:19], v8, s[40:43], s54 offen sc1
s_mov_b64 exec, -1
L_nofin_31:
v_mov_b32 v8, 0
ds_read_b32 v8, v8 offset:404
s_waitcnt lgkmcnt(0)
v_readfirstlane_b32 s71, v8
s_cmp_eq_u32 s59, 0xff
s_cselect_b32 s67, 0, s59
s_mul_i32 s54, s58, 352256
s_lshl_b32 s55, s67, 6
s_add_u32 s64, s54, s55
s_add_u32 s32, s16, s64
s_addc_u32 s33, s17, 0
s_sub_u32 s34, 1409024, s64
s_mov_b32 s35, 0x20000
s_lshl_b32 s54, s67, 15
s_lshl_b32 s55, s58, 8
s_add_u32 s64, s54, s55
s_add_u32 s36, s18, s64
s_addc_u32 s37, s19, 0
s_sub_u32 s38, 1409024, s64
s_mov_b32 s39, 0x20000
v_lshrrev_b32 v205, 2, v0
v_mul_u32_u24 v205, 2752, v205
v_and_b32 v10, 3, v0
v_lshlrev_b32 v10, 4, v10
v_add_u32 v205, v205, v10
s_lshl_b32 s65, s58, 13
s_add_u32 s65, s65, 53248
s_add_u32 s66, s65, 32768
v_lshlrev_b32 v206, 10, v3
v_lshlrev_b32 v11, 4, v2
v_add_u32 v206, v206, v11
v_mov_b32 v199, 0
v_mov_b32 v200, 0
v_mov_b32 v213, 0
s_mov_b32 s68, 0
s_mov_b32 s70, 0
v_mov_b32 v12, 0
L_lw_38:
ds_read_b32 v13, v12 offset:408
s_waitcnt lgkmcnt(0)
v_readfirstlane_b32 s47, v13
s_add_u32 s70, s70, 1
s_cmp_gt_u32 s70, 1600004
s_cbranch_scc1 L_lwd_39
s_cmp_lt_u32 s47, 4
s_cbranch_scc1 L_lw_38
L_lwd_39:
s_cmp_eq_u32 s59, 0xff
s_cbranch_scc1 L_woprep_35
v_lshrrev_b32 v5, 5, v0
v_and_b32 v8, 31, v0
s_lshl_b32 s68, s58, 9
v_lshlrev_b32 v9, 11, v5
v_lshlrev_b32 v10, 4, v8
v_add_u32 v9, v9, v10
v_add_u32 v9, s68, v9
s_mov_b32 s54, 102400
s_mov_b32 s55, 106496
s_mov_b32 s56, 110592
v_mov_b32 v202, v9
v_lshrrev_b32 v7, 2, v0
v_and_b32 v7, 1, v7
v_lshlrev_b32 v199, 11, v7
v_and_b32 v7, 3, v0
v_lshlrev_b32 v7, 4, v7
v_add_u32 v199, v199, v7
s_and_b32 s57, s59, 31
s_lshl_b32 s57, s57, 6
v_add_u32 v199, s57, v199
s_mov_b32 s69, 114688
s_mov_b32 s70, 0
L_p_modf_41:
buffer_load_dwordx4 v[12:15], v9, s[40:43], s54 offen sc1
buffer_load_dwordx4 v[16:19], v9, s[40:43], s55 offen sc1
buffer_load_dwordx4 v[20:23], v9, s[40:43], s56 offen sc1
buffer_load_dwordx4 v[236:239], v199, s[40:43], s69 offen sc1
s_waitcnt vmcnt(0)
v_xor_b32 v12, v12, v1
v_xor_b32 v13, v13, v1
v_xor_b32 v14, v14, v1
v_xor_b32 v15, v15, v1
v_xor_b32 v16, v16, v1
v_xor_b32 v17, v17, v1
v_xor_b32 v18, v18, v1
v_xor_b32 v19, v19, v1
v_xor_b32 v20, v20, v1
v_xor_b32 v21, v21, v1
v_xor_b32 v22, v22, v1
v_xor_b32 v23, v23, v1
v_xor_b32 v236, v236, v1
v_xor_b32 v237, v237, v1
v_xor_b32 v238, v238, v1
v_xor_b32 v239, v239, v1
v_or_b32 v28, v12, v13
v_or3_b32 v28, v28, v14, v15
v_or3_b32 v28, v28, v16, v17
v_or3_b32 v28, v28, v18, v19
v_or3_b32 v28, v28, v20, v21
v_or3_b32 v28, v28, v22, v23
v_or3_b32 v28, v28, v236, v237
v_or3_b32 v28, v28, v238, v239
v_and_b32 v28, 1023, v28
v_cmp_ne_u32 vcc, 0, v28
s_add_u32 s70, s70, 1
s_cmp_gt_u32 s70, 400000
s_cbranch_scc1 L_p_modf_done_40
s_cbranch_vccnz L_p_modf_41
L_p_modf_done_40:
s_mov_b32 s72, s4
s_mov_b32 s73, s5
s_mov_b32 s74, 2048
s_mov_b32 s75, 0x20000
v_lshrrev_b32 v10, 1, v9
buffer_load_dwordx2 v[40:41], v10, s[72:75], 0 offen
v_and_b32 v228, v4, v12
v_and_b32 v16, v4, v16
v_and_b32 v20, v4, v20
v_and_b32 v236, v4, v236
v_add_f32 v20, 1.0, v20
v_and_b32 v229, v4, v13
v_and_b32 v17, v4, v17
v_and_b32 v21, v4, v21
v_and_b32 v237, v4, v237
v_add_f32 v21, 1.0, v21
v_and_b32 v230, v4, v14
v_and_b32 v18, v4, v18
v_and_b32 v22, v4, v22
v_and_b32 v238, v4, v238
v_add_f32 v22, 1.0, v22
v_and_b32 v231, v4, v15
v_and_b32 v19, v4, v19
v_and_b32 v23, v4, v23
v_and_b32 v239, v4, v239
v_add_f32 v23, 1.0, v23
s_mul_i32 s68, s58, 1536
s_add_u32 s68, s68, 10240
v_lshlrev_b32 v201, 8, v5
v_lshlrev_b32 v10, 3, v8
v_add_u32 v201, v201, v10
v_add_u32 v201, s68, v201
v_cvt_pk_bf16_f32 v42, v20, v21
v_cvt_pk_bf16_f32 v43, v22, v23
v_cvt_pk_bf16_f32 v44, v16, v17
v_cvt_pk_bf16_f32 v45, v18, v19
v_lshlrev_b32 v232, 16, v42
v_and_b32 v233, 0xffff0000, v42
v_lshlrev_b32 v234, 16, v43
v_and_b32 v235, 0xffff0000, v43
ds_write_b64 v201, v[42:43] offset:512
ds_write_b64 v201, v[44:45] offset:1024
s_waitcnt vmcnt(0)
v_lshlrev_b32 v224, 16, v40
v_and_b32 v225, 0xffff0000, v40
v_lshlrev_b32 v226, 16, v41
v_and_b32 v227, 0xffff0000, v41
v_lshlrev_b32 v207, 3, v3
v_lshrrev_b32 v12, 2, v2
v_add_u32 v207, v207, v12
v_lshlrev_b32 v207, 6, v207
v_and_b32 v12, 3, v2
v_lshlrev_b32 v12, 3, v12
v_add_u32 v207, v207, v12
v_add_u32 v207, s65, v207
s_lshl_b32 s78, s58, 12
s_add_u32 s78, s78, 20480
v_lshlrev_b32 v198, 3, v3
v_lshrrev_b32 v12, 2, v2
v_add_u32 v198, v198, v12
v_lshlrev_b32 v198, 6, v198
v_and_b32 v12, 3, v2
v_lshlrev_b32 v12, 3, v12
v_add_u32 v198, v198, v12
v_add_u32 v198, s78, v198
s_mov_b32 s56, 0
s_add_u32 s57, s78, 0
s_mov_b32 m0, s57
s_nop 0
buffer_load_dwordx4 v205, s[32:35], s56 offen nt lds
s_mov_b32 s56, 44032
s_add_u32 s57, s78, 1024
s_mov_b32 m0, s57
s_nop 0
buffer_load_dwordx4 v205, s[32:35], s56 offen nt lds
s_waitcnt vmcnt(1)
s_mov_b32 s56, 88064
s_add_u32 s57, s78, 2048
s_mov_b32 m0, s57
s_nop 0
buffer_load_dwordx4 v205, s[32:35], s56 offen nt lds
s_waitcnt vmcnt(1)
s_mov_b32 s56, 132096
s_add_u32 s57, s78, 3072
s_mov_b32 m0, s57
s_nop 0
buffer_load_dwordx4 v205, s[32:35], s56 offen nt lds
v_lshlrev_b32 v208, 3, v3
v_lshrrev_b32 v12, 2, v2
v_add_u32 v208, v208, v12
v_lshlrev_b32 v208, 8, v208
v_and_b32 v12, 3, v2
v_lshlrev_b32 v12, 3, v12
v_add_u32 v208, v208, v12
v_add_u32 v208, s66, v208
v_lshrrev_b32 v200, 2, v8
v_lshlrev_b32 v200, 7, v200
v_and_b32 v12, 3, v8
v_lshlrev_b32 v12, 4, v12
v_add_u32 v200, v200, v12
v_lshlrev_b32 v12, 6, v5
v_add_u32 v200, v200, v12
s_lshl_b32 s54, s58, 10
v_add_u32 v200, s54, v200
v_cmp_gt_u32 vcc, 6, v2
s_nop 1
v_cndmask_b32 v203, 0, v2, vcc
v_lshlrev_b32 v203, 8, v203
v_lshlrev_b32 v12, 4, v3
v_add_u32 v203, v203, v12
v_add_u32 v203, s68, v203
s_lshl_b32 s54, s58, 10
v_lshlrev_b32 v204, 4, v0
v_add_u32 v204, s54, v204
v_lshrrev_b32 v10, 4, v8
v_lshlrev_b32 v10, 9, v10
v_lshlrev_b32 v11, 4, v2
v_add_u32 v10, v10, v11
v_lshlrev_b32 v11, 2, v5
v_add_u32 v209, v10, v11
v_lshlrev_b32 v210, 5, v5
s_lshl_b32 s54, s58, 3
v_add_u32 v214, s54, v210
s_lshl_b32 s54, s58, 7
v_lshlrev_b32 v211, 1, v0
v_add_u32 v211, s54, v211
v_and_b32 v14, 1, v2
v_lshlrev_b32 v14, 6, v14
v_lshlrev_b32 v15, 4, v3
v_add_u32 v14, v14, v15
v_add_u32 v212, s54, v14
v_lshlrev_b32 v213, 6, v2
v_lshlrev_b32 v9, 4, v3
v_add_u32 v213, v213, v9
s_lshl_b32 s68, s59, 12
s_lshl_b32 s55, s58, 10
s_add_u32 s68, s68, s55
s_add_u32 s68, s68, 622592
L_woprep_35:
s_lshl_b32 s64, s50, 17
s_lshl_b32 s77, s58, 15
s_add_u32 s64, s64, s77
s_lshl_b32 s77, s51, 7
s_add_u32 s64, s64, s77
s_add_u32 s72, s12, s64
s_addc_u32 s73, s13, 0
s_sub_u32 s74, 4194304, s64
s_mov_b32 s75, 0x20000
v_lshrrev_b32 v215, 3, v0
v_lshlrev_b32 v215, 10, v215
v_and_b32 v10, 7, v0
v_lshlrev_b32 v10, 4, v10
v_add_u32 v215, v215, v10
s_lshl_b32 s77, s58, 12
s_add_u32 s77, s77, 36864
s_lshl_b32 s54, s50, 10
s_add_u32 s54, s54, 131072
v_and_b32 v8, 1, v3
v_lshlrev_b32 v8, 9, v8
v_and_b32 v9, 3, v0
v_lshlrev_b32 v9, 7, v9
v_add_u32 v8, v8, v9
s_mul_i32 s55, s31, 0x00400401
v_mov_b32 v5, s55
s_mov_b32 s70, 0
L_p_ml_43:
buffer_load_dwordx4 v[12:15], v8, s[40:43], s54 offen sc1
s_waitcnt vmcnt(0)
v_xor_b32 v16, v14, v5
v_sub_u32 v17, v15, v5
v_lshrrev_b32 v18, 4, v17
v_or_b32 v16, v16, v18
v_cmp_ne_u32 vcc, 0, v16
s_add_u32 s70, s70, 1
s_cmp_gt_u32 s70, 400000
s_cbranch_scc1 L_p_ml_done_42
s_cbranch_vccnz L_p_ml_43
L_p_ml_done_42:
v_mov_b32 v16, v12
s_nop 1
v_max_f32_dpp v16, v16, v16 quad_perm:[1,0,3,2] row_mask:0xf bank_mask:0xf
s_nop 1
v_max_f32_dpp v16, v16, v16 quad_perm:[2,3,0,1] row_mask:0xf bank_mask:0xf
v_sub_f32 v12, v12, v16
v_exp_f32 v12, v12
s_nop 0
v_mul_f32 v13, v13, v12
s_nop 1
v_add_f32_dpp v13, v13, v13 quad_perm:[1,0,3,2] row_mask:0xf bank_mask:0xf
s_nop 1
v_add_f32_dpp v13, v13, v13 quad_perm:[2,3,0,1] row_mask:0xf bank_mask:0xf
v_rcp_f32 v13, v13
s_nop 0
v_mul_f32 v12, v12, v13
s_nop 1
v_mov_b32_dpp v240, v12 quad_perm:[0,0,0,0] row_mask:0xf bank_mask:0xf
v_mov_b32_dpp v241, v12 quad_perm:[1,1,1,1] row_mask:0xf bank_mask:0xf
v_mov_b32_dpp v242, v12 quad_perm:[2,2,2,2] row_mask:0xf bank_mask:0xf
v_mov_b32_dpp v243, v12 quad_perm:[3,3,3,3] row_mask:0xf bank_mask:0xf
v_lshlrev_b32 v216, 3, v3
v_lshrrev_b32 v12, 2, v2
v_add_u32 v216, v216, v12
v_lshlrev_b32 v216, 7, v216
v_and_b32 v12, 3, v2
v_lshlrev_b32 v12, 3, v12
v_add_u32 v216, v216, v12
s_lshl_b32 s54, s58, 5
s_add_u32 s54, s54, 36864
v_add_u32 v216, s54, v216
s_lshl_b32 s64, s50, 11
s_add_u32 s64, s64, 458752
s_lshl_b32 s55, s58, 6
s_add_u32 s64, s64, s55
v_and_b32 v217, 7, v2
v_lshlrev_b32 v217, 8, v217
v_lshlrev_b32 v7, 4, v3
v_add_u32 v217, v217, v7
v_and_b32 v219, 7, v2
v_lshlrev_b32 v219, 4, v219
v_lshlrev_b32 v9, 7, v3
v_add_u32 v219, v219, v9
s_lshl_b32 s55, s58, 9
v_add_u32 v220, s55, v219
v_lshlrev_b32 v218, 6, v3
v_lshlrev_b32 v9, 2, v2
v_add_u32 v218, v218, v9
s_lshl_b32 s76, s48, 14
s_lshl_b32 s55, s51, 11
s_add_u32 s76, s76, s55
s_add_u32 s76, s76, 851968
s_and_b32 s55, s49, 3
s_lshl_b32 s55, s55, 9
s_add_u32 s76, s76, s55
s_lshl_b32 s55, s58, 7
s_add_u32 s76, s76, s55
s_mov_b32 s70, 0
v_mov_b32 v12, 0
L_lw_44:
ds_read_b32 v13, v12 offset:412
s_waitcnt lgkmcnt(0)
v_readfirstlane_b32 s47, v13
s_add_u32 s70, s70, 1
s_cmp_gt_u32 s70, 1600004
s_cbranch_scc1 L_lwd_45
s_cmp_lt_u32 s47, 4
s_cbranch_scc1 L_lw_44
L_lwd_45:
s_mov_b32 s56, 0
s_add_u32 m0, s77, 0
s_nop 0
buffer_load_dwordx4 v215, s[72:75], s56 offen nt lds
s_mov_b32 s56, 8192
s_add_u32 m0, s77, 1024
s_nop 0
buffer_load_dwordx4 v215, s[72:75], s56 offen nt lds
s_mov_b32 s56, 16384
s_add_u32 m0, s77, 2048
s_nop 0
buffer_load_dwordx4 v215, s[72:75], s56 offen nt lds
s_mov_b32 s56, 24576
s_add_u32 m0, s77, 3072
s_nop 0
buffer_load_dwordx4 v215, s[72:75], s56 offen nt lds
s_cmp_eq_u32 s59, 0xff
s_cbranch_scc1 L_now1_46
s_mov_b32 s56, 176128
s_add_u32 s57, s65, 4096
s_mov_b32 m0, s57
s_nop 0
buffer_load_dwordx4 v205, s[32:35], s56 offen nt lds
s_mov_b32 s56, 220160
s_add_u32 s57, s65, 5120
s_mov_b32 m0, s57
s_nop 0
buffer_load_dwordx4 v205, s[32:35], s56 offen nt lds
s_mov_b32 s56, 264192
s_add_u32 s57, s65, 6144
s_mov_b32 m0, s57
s_nop 0
buffer_load_dwordx4 v205, s[32:35], s56 offen nt lds
s_mov_b32 s56, 308224
s_add_u32 s57, s65, 7168
s_mov_b32 m0, s57
s_nop 0
buffer_load_dwordx4 v205, s[32:35], s56 offen nt lds
s_waitcnt vmcnt(4)
s_branch L_w1q_47
L_now1_46:
s_waitcnt vmcnt(0)
L_w1q_47:
s_mov_b64 exec, 1
v_mov_b32 v12, 0
v_mov_b32 v13, 1
ds_add_u32 v12, v13 offset:396
s_mov_b64 exec, -1
s_mov_b32 s70, 0
v_mov_b32 v12, 0
L_lw_48:
ds_read_b32 v13, v12 offset:396
s_waitcnt lgkmcnt(0)
v_readfirstlane_b32 s47, v13
s_add_u32 s70, s70, 1
s_cmp_gt_u32 s70, 1600004
s_cbranch_scc1 L_lwd_49
s_cmp_lt_u32 s47, 4
s_cbranch_scc1 L_lw_48
L_lwd_49:
ds_read_b64_tr_b16 v[128:129], v216 offset:0
ds_read_b64_tr_b16 v[130:131], v216 offset:512
ds_read_b64_tr_b16 v[132:133], v216 offset:4096
ds_read_b64_tr_b16 v[134:135], v216 offset:4608
ds_read_b64_tr_b16 v[136:137], v216 offset:8192
ds_read_b64_tr_b16 v[138:139], v216 offset:8704
ds_read_b64_tr_b16 v[140:141], v216 offset:12288
ds_read_b64_tr_b16 v[142:143], v216 offset:12800
s_waitcnt lgkmcnt(0)
s_mov_b32 exec_lo, 0x00ff00ff
s_mov_b32 exec_hi, 0x00ff00ff
s_mov_b32 s70, 0
L_p_o_51:
buffer_load_dwordx4 v[16:19], v217, s[40:43], s64 offen sc1
s_waitcnt vmcnt(0)
v_max_u32 v12, v16, v17
v_max3_u32 v12, v12, v18, v19
v_cmp_eq_u32 vcc, -1, v12
s_add_u32 s70, s70, 1
s_cmp_gt_u32 s70, 400000
s_cbranch_scc1 L_p_o_done_50
s_cbranch_vccnz L_p_o_51
L_p_o_done_50:
ds_write_b128 v220, v[16:19] offset:2560
s_mov_b64 exec, 1
v_mov_b32 v12, 0
v_mov_b32 v13, 1
ds_add_u32 v12, v13 offset:400
s_mov_b64 exec, -1
s_mov_b32 s70, 0
v_mov_b32 v12, 0
L_lw_52:
ds_read_b32 v13, v12 offset:400
s_waitcnt lgkmcnt(0)
v_readfirstlane_b32 s47, v13
s_add_u32 s70, s70, 1
s_cmp_gt_u32 s70, 1600004
s_cbranch_scc1 L_lwd_53
s_cmp_lt_u32 s47, 4
s_cbranch_scc1 L_lw_52
L_lwd_53:
ds_read_b128 v[16:19], v219 offset:2560
ds_read_b128 v[20:23], v219 offset:3072
ds_read_b128 v[24:27], v219 offset:3584
ds_read_b128 v[28:31], v219 offset:4096
s_waitcnt lgkmcnt(0)
v_mfma_f32_16x16x32_bf16 v[32:35], v[16:19], v[128:131], 0
v_mfma_f32_16x16x32_bf16 v[32:35], v[20:23], v[132:135], v[32:35]
v_mfma_f32_16x16x32_bf16 v[32:35], v[24:27], v[136:139], v[32:35]
v_mfma_f32_16x16x32_bf16 v[32:35], v[28:31], v[140:143], v[32:35]
s_mov_b32 exec_hi, 0
s_nop 6
v_mul_f32 v32, v32, v240
v_fmac_f32 v32, v33, v241
v_fmac_f32 v32, v34, v242
v_fmac_f32 v32, v35, v243
v_and_or_b32 v32, v32, v4, v1
s_cmp_eq_u32 s71, 0
s_cbranch_scc1 L_wt_54
buffer_store_dword v32, v218, s[40:43], s76 offen
s_branch L_wte_55
L_wt_54:
buffer_store_dword v32, v218, s[40:43], s76 offen sc1
L_wte_55:
s_mov_b64 exec, -1
s_cmp_lg_u32 s59, 0xff
s_cbranch_scc1 L_t3_36
s_cmp_ge_u32 s49, 8
s_cbranch_scc1 L_exit
s_cmp_lg_u32 s58, 0
s_cbranch_scc1 L_exit
s_lshl_b32 s66, s48, 14
s_lshl_b32 s55, s49, 11
s_add_u32 s66, s66, s55
s_add_u32 s66, s66, 851968
s_lshl_b32 s67, s48, 12
s_lshl_b32 s55, s49, 9
s_add_u32 s67, s67, s55
s_add_u32 s67, s67, 524288
v_lshlrev_b32 v8, 4, v0
s_mov_b32 s70, 0
L_p_yp_57:
buffer_load_dwordx4 v[16:19], v8, s[40:43], s66 offen sc1
buffer_load_dwordx4 v[20:23], v8, s[40:43], s66 offen offset:1024 sc1
s_waitcnt vmcnt(0)
v_xor_b32 v16, v16, v1
v_xor_b32 v17, v17, v1
v_xor_b32 v18, v18, v1
v_xor_b32 v19, v19, v1
v_xor_b32 v20, v20, v1
v_xor_b32 v21, v21, v1
v_xor_b32 v22, v22, v1
v_xor_b32 v23, v23, v1
v_or_b32 v12, v16, v17
v_or3_b32 v12, v12, v18, v19
v_or3_b32 v12, v12, v20, v21
v_or3_b32 v12, v12, v22, v23
v_and_b32 v12, 1023, v12
v_cmp_ne_u32 vcc, 0, v12
s_add_u32 s70, s70, 1
s_cmp_gt_u32 s70, 400000
s_cbranch_scc1 L_p_yp_done_56
s_cbranch_vccnz L_p_yp_57
L_p_yp_done_56:
v_pk_add_f32 v[16:17], v[16:17], v[20:21]
v_pk_add_f32 v[18:19], v[18:19], v[22:23]
s_nop 0
v_mov_b32 v20, v16
v_mov_b32 v21, v17
v_mov_b32 v22, v18
v_mov_b32 v23, v19
s_nop 1
v_permlane32_swap_b32 v16, v20
v_permlane32_swap_b32 v17, v21
v_permlane32_swap_b32 v18, v22
v_permlane32_swap_b32 v19, v23
s_nop 1
v_add_f32 v16, v16, v20
v_add_f32 v17, v17, v21
v_add_f32 v18, v18, v22
v_add_f32 v19, v19, v23
v_and_or_b32 v16, v16, v4, v1
v_and_or_b32 v17, v17, v4, v1
v_and_or_b32 v18, v18, v4, v1
v_and_or_b32 v19, v19, v4, v1
s_mov_b32 exec_hi, 0
buffer_store_dwordx4 v[16:19], v8, s[40:43], s67 offen sc1
s_endpgm
L_t3_36:
s_mov_b32 s56, 0
s_add_u32 s57, s66, 0
s_mov_b32 m0, s57
s_nop 0
buffer_load_dwordx4 v206, s[36:39], s56 offen nt lds
s_mov_b32 s56, 4096
s_add_u32 s57, s66, 1024
s_mov_b32 m0, s57
s_nop 0
buffer_load_dwordx4 v206, s[36:39], s56 offen nt lds
s_mov_b32 s56, 8192
s_add_u32 s57, s66, 2048
s_mov_b32 m0, s57
s_nop 0
buffer_load_dwordx4 v206, s[36:39], s56 offen nt lds
s_mov_b32 s56, 12288
s_add_u32 s57, s66, 3072
s_mov_b32 m0, s57
s_nop 0
buffer_load_dwordx4 v206, s[36:39], s56 offen nt lds
s_mov_b32 s56, 16384
s_add_u32 s57, s66, 4096
s_mov_b32 m0, s57
s_nop 0
buffer_load_dwordx4 v206, s[36:39], s56 offen nt lds
s_mov_b32 s56, 20480
s_add_u32 s57, s66, 5120
s_mov_b32 m0, s57
s_nop 0
buffer_load_dwordx4 v206, s[36:39], s56 offen nt lds
s_mov_b32 s56, 24576
s_add_u32 s57, s66, 6144
s_mov_b32 m0, s57
s_nop 0
buffer_load_dwordx4 v206, s[36:39], s56 offen nt lds
s_mov_b32 s56, 28672
s_add_u32 s57, s66, 7168
s_mov_b32 m0, s57
s_nop 0
buffer_load_dwordx4 v206, s[36:39], s56 offen nt lds
s_waitcnt vmcnt(8)
ds_read_b64_tr_b16 v[64:65], v198 offset:0
ds_read_b64_tr_b16 v[66:67], v198 offset:256
ds_read_b64_tr_b16 v[68:69], v198 offset:2048
ds_read_b64_tr_b16 v[70:71], v198 offset:2304
ds_read_b64_tr_b16 v[72:73], v207 offset:4096
ds_read_b64_tr_b16 v[74:75], v207 offset:4352
ds_read_b64_tr_b16 v[76:77], v207 offset:6144
ds_read_b64_tr_b16 v[78:79], v207 offset:6400
ds_read_b64_tr_b16 v[80:81], v198 offset:32
ds_read_b64_tr_b16 v[82:83], v198 offset:288
ds_read_b64_tr_b16 v[84:85], v198 offset:2080
ds_read_b64_tr_b16 v[86:87], v198 offset:2336
ds_read_b64_tr_b16 v[88:89], v207 offset:4128
ds_read_b64_tr_b16 v[90:91], v207 offset:4384
ds_read_b64_tr_b16 v[92:93], v207 offset:6176
ds_read_b64_tr_b16 v[94:95], v207 offset:6432
s_waitcnt vmcnt(0)
ds_read_b64_tr_b16 v[96:97], v208 offset:0
ds_read_b64_tr_b16 v[98:99], v208 offset:1024
ds_read_b64_tr_b16 v[100:101], v208 offset:32
ds_read_b64_tr_b16 v[102:103], v208 offset:1056
ds_read_b64_tr_b16 v[104:105], v208 offset:64
ds_read_b64_tr_b16 v[106:107], v208 offset:1088
ds_read_b64_tr_b16 v[108:109], v208 offset:96
ds_read_b64_tr_b16 v[110:111], v208 offset:1120
ds_read_b64_tr_b16 v[112:113], v208 offset:128
ds_read_b64_tr_b16 v[114:115], v208 offset:1152
ds_read_b64_tr_b16 v[116:117], v208 offset:160
ds_read_b64_tr_b16 v[118:119], v208 offset:1184
ds_read_b64_tr_b16 v[120:121], v208 offset:192
ds_read_b64_tr_b16 v[122:123], v208 offset:1216
ds_read_b64_tr_b16 v[124:125], v208 offset:224
ds_read_b64_tr_b16 v[126:127], v208 offset:1248
s_waitcnt lgkmcnt(0)
s_mov_b32 s70, 0
L_p_y_58:
s_mov_b32 s55, 524288
buffer_load_dwordx4 v[16:19], v200, s[40:43], s55 offen sc1
s_mov_b32 s55, 528384
buffer_load_dwordx4 v[20:23], v200, s[40:43], s55 offen sc1
s_mov_b32 s55, 532480
buffer_load_dwordx4 v[24:27], v200, s[40:43], s55 offen sc1
s_mov_b32 s55, 536576
buffer_load_dwordx4 v[28:31], v200, s[40:43], s55 offen sc1
s_mov_b32 s55, 540672
buffer_load_dwordx4 v[32:35], v200, s[40:43], s55 offen sc1
s_mov_b32 s55, 544768
buffer_load_dwordx4 v[36:39], v200, s[40:43], s55 offen sc1
s_mov_b32 s55, 548864
buffer_load_dwordx4 v[40:43], v200, s[40:43], s55 offen sc1
s_mov_b32 s55, 552960
buffer_load_dwordx4 v[44:47], v200, s[40:43], s55 offen sc1
s_waitcnt vmcnt(4)
v_xor_b32 v16, v16, v1
v_xor_b32 v17, v17, v1
v_xor_b32 v18, v18, v1
v_xor_b32 v19, v19, v1
v_xor_b32 v20, v20, v1
v_xor_b32 v21, v21, v1
v_xor_b32 v22, v22, v1
v_xor_b32 v23, v23, v1
v_xor_b32 v24, v24, v1
v_xor_b32 v25, v25, v1
v_xor_b32 v26, v26, v1
v_xor_b32 v27, v27, v1
v_xor_b32 v28, v28, v1
v_xor_b32 v29, v29, v1
v_xor_b32 v30, v30, v1
v_xor_b32 v31, v31, v1
v_or_b32 v12, v16, v17
v_or3_b32 v12, v12, v18, v19
v_or3_b32 v12, v12, v20, v21
v_or3_b32 v12, v12, v22, v23
v_or3_b32 v12, v12, v24, v25
v_or3_b32 v12, v12, v26, v27
v_or3_b32 v12, v12, v28, v29
v_or3_b32 v12, v12, v30, v31
s_waitcnt vmcnt(0)
v_xor_b32 v32, v32, v1
v_xor_b32 v33, v33, v1
v_xor_b32 v34, v34, v1
v_xor_b32 v35, v35, v1
v_xor_b32 v36, v36, v1
v_xor_b32 v37, v37, v1
v_xor_b32 v38, v38, v1
v_xor_b32 v39, v39, v1
v_xor_b32 v40, v40, v1
v_xor_b32 v41, v41, v1
v_xor_b32 v42, v42, v1
v_xor_b32 v43, v43, v1
v_xor_b32 v44, v44, v1
v_xor_b32 v45, v45, v1
v_xor_b32 v46, v46, v1
v_xor_b32 v47, v47, v1
v_or3_b32 v12, v12, v32, v33
v_or3_b32 v12, v12, v34, v35
v_or3_b32 v12, v12, v36, v37
v_or3_b32 v12, v12, v38, v39
v_or3_b32 v12, v12, v40, v41
v_or3_b32 v12, v12, v42, v43
v_or3_b32 v12, v12, v44, v45
v_or3_b32 v12, v12, v46, v47
v_and_b32 v12, 1023, v12
v_cmp_ne_u32 vcc, 0, v12
s_add_u32 s70, s70, 1
s_cmp_gt_u32 s70, 400000
s_cbranch_scc1 L_p_y_done_59
s_cbranch_vccnz L_p_y_58
L_p_y_done_59:
s_or_b32 s54, s59, s58
s_cmp_lg_u32 s54, 0
s_cbranch_scc1 L_noep_60
s_add_u32 s30, s30, 1
v_mov_b32 v12, 0
v_mov_b32 v13, s30
s_mov_b64 exec, 1
buffer_store_dword v13, v12, s[40:43], 0 offen
s_mov_b64 exec, -1
L_noep_60:
v_pk_add_f32 v[16:17], v[16:17], v[20:21]
v_pk_add_f32 v[24:25], v[24:25], v[28:29]
v_pk_add_f32 v[32:33], v[32:33], v[36:37]
v_pk_add_f32 v[40:41], v[40:41], v[44:45]
v_pk_add_f32 v[18:19], v[18:19], v[22:23]
v_pk_add_f32 v[26:27], v[26:27], v[30:31]
v_pk_add_f32 v[34:35], v[34:35], v[38:39]
v_pk_add_f32 v[42:43], v[42:43], v[46:47]
v_pk_add_f32 v[16:17], v[16:17], v[24:25]
v_pk_add_f32 v[32:33], v[32:33], v[40:41]
v_pk_add_f32 v[18:19], v[18:19], v[26:27]
v_pk_add_f32 v[34:35], v[34:35], v[42:43]
v_pk_add_f32 v[16:17], v[16:17], v[32:33]
v_pk_add_f32 v[18:19], v[18:19], v[34:35]
v_pk_fma_f32 v[16:17], v[16:17], v[228:229], v[224:225]
v_pk_fma_f32 v[18:19], v[18:19], v[230:231], v[226:227]
v_pk_mul_f32 v[24:25], v[16:17], v[232:233]
v_pk_mul_f32 v[26:27], v[18:19], v[234:235]
v_cvt_pk_bf16_f32 v24, v24, v25
v_cvt_pk_bf16_f32 v25, v26, v27
ds_write_b64 v201, v[24:25]
ds_read_b128 v[28:31], v203 offset:0
ds_read_b128 v[32:35], v203 offset:64
ds_read_b128 v[36:39], v203 offset:128
ds_read_b128 v[40:43], v203 offset:192
ds_write_b128 v202, v[16:19] offset:16384
v_pk_add_f32 v[20:21], v[16:17], v[18:19]
v_mul_f32 v49, v16, v16
v_add_f32 v48, v20, v21
v_fmac_f32 v49, v17, v17
v_fmac_f32 v49, v18, v18
v_fmac_f32 v49, v19, v19
s_nop 1
v_add_f32_dpp v48, v48, v48 row_ror:8 row_mask:0xf bank_mask:0xf
v_add_f32_dpp v49, v49, v49 row_ror:8 row_mask:0xf bank_mask:0xf
s_nop 1
v_add_f32_dpp v48, v48, v48 row_ror:4 row_mask:0xf bank_mask:0xf
v_add_f32_dpp v49, v49, v49 row_ror:4 row_mask:0xf bank_mask:0xf
s_nop 1
v_add_f32_dpp v48, v48, v48 row_ror:2 row_mask:0xf bank_mask:0xf
v_add_f32_dpp v49, v49, v49 row_ror:2 row_mask:0xf bank_mask:0xf
s_nop 1
v_add_f32_dpp v48, v48, v48 row_ror:1 row_mask:0xf bank_mask:0xf
v_add_f32_dpp v49, v49, v49 row_ror:1 row_mask:0xf bank_mask:0xf
s_waitcnt lgkmcnt(1)
v_mfma_f32_16x16x32_bf16 v[16:19], v[28:31], v[64:67], 0
v_mfma_f32_16x16x32_bf16 v[20:23], v[28:31], v[80:83], 0
v_mfma_f32_16x16x32_bf16 v[16:19], v[32:35], v[68:71], v[16:19]
v_mfma_f32_16x16x32_bf16 v[20:23], v[32:35], v[84:87], v[20:23]
v_mfma_f32_16x16x32_bf16 v[16:19], v[36:39], v[72:75], v[16:19]
v_mfma_f32_16x16x32_bf16 v[20:23], v[36:39], v[88:91], v[20:23]
v_mfma_f32_16x16x32_bf16 v[16:19], v[40:43], v[76:79], v[16:19]
v_mfma_f32_16x16x32_bf16 v[20:23], v[40:43], v[92:95], v[20:23]
s_nop 0
v_mov_b32 v50, v48
v_mov_b32 v51, v49
s_nop 1
v_permlane16_swap_b32 v48, v50
v_permlane16_swap_b32 v49, v51
s_nop 1
v_add_f32 v48, v48, v50
v_add_f32 v49, v49, v51
s_mov_b32 exec_lo, 1
s_mov_b32 exec_hi, 1
ds_write_b64 v214, v[48:49] offset:8704
s_mov_b32 exec_lo, -1
s_mov_b32 exec_hi, 0
ds_write_b128 v204, v[16:19] offset:4608
ds_write_b128 v204, v[20:23] offset:5120
s_mov_b64 exec, -1
s_waitcnt lgkmcnt(0)
s_barrier
ds_read_b32 v12, v209 offset:4608
ds_read_b32 v16, v209 offset:4616
ds_read_b32 v20, v209 offset:4864
ds_read_b32 v13, v209 offset:5632
ds_read_b32 v17, v209 offset:5640
ds_read_b32 v21, v209 offset:5888
ds_read_b32 v14, v209 offset:6656
ds_read_b32 v18, v209 offset:6664
ds_read_b32 v22, v209 offset:6912
ds_read_b32 v15, v209 offset:7680
ds_read_b32 v19, v209 offset:7688
ds_read_b32 v23, v209 offset:7936
ds_read_b128 v[24:27], v210 offset:8704
ds_read_b128 v[28:31], v210 offset:8720
s_waitcnt lgkmcnt(0)
v_pk_add_f32 v[24:25], v[24:25], v[26:27]
v_pk_add_f32 v[28:29], v[28:29], v[30:31]
v_pk_add_f32 v[12:13], v[12:13], v[14:15]
v_pk_add_f32 v[16:17], v[16:17], v[18:19]
v_pk_add_f32 v[20:21], v[20:21], v[22:23]
v_pk_add_f32 v[24:25], v[24:25], v[28:29]
v_add_f32 v12, v12, v13
v_add_f32 v16, v16, v17
v_add_f32 v20, v20, v21
v_mul_f32 v24, 0x3b000000, v24
v_mul_f32 v25, 0x3b000000, v25
v_fma_f32 v25, -v24, v24, v25
v_add_f32 v25, 0x3727c5ac, v25
v_rsq_f32 v25, v25
v_fma_f32 v12, -v24, v16, v12
v_fma_f32 v12, v12, v25, v20
v_mul_f32 v13, 0xbfb8aa3b, v12
v_exp_f32 v13, v13
s_nop 0
v_add_f32 v13, 1.0, v13
v_rcp_f32 v13, v13
s_nop 0
v_mul_f32 v12, v12, v13
v_cvt_pk_bf16_f32 v12, v12, v12
ds_write_b16 v211, v12 offset:9728
ds_read_b128 v[16:19], v212 offset:9728
s_waitcnt lgkmcnt(0)
v_mfma_f32_16x16x32_bf16 v[128:131], v[96:99], v[16:19], 0
v_mfma_f32_16x16x32_bf16 v[132:135], v[100:103], v[16:19], 0
v_mfma_f32_16x16x32_bf16 v[136:139], v[104:107], v[16:19], 0
v_mfma_f32_16x16x32_bf16 v[140:143], v[108:111], v[16:19], 0
v_mfma_f32_16x16x32_bf16 v[144:147], v[112:115], v[16:19], 0
v_mfma_f32_16x16x32_bf16 v[148:151], v[116:119], v[16:19], 0
v_mfma_f32_16x16x32_bf16 v[152:155], v[120:123], v[16:19], 0
v_mfma_f32_16x16x32_bf16 v[156:159], v[124:127], v[16:19], 0
s_mov_b32 exec_lo, 0x00030003
s_mov_b32 exec_hi, 0x00030003
v_and_or_b32 v128, v128, v4, v1
v_and_or_b32 v129, v129, v4, v1
v_and_or_b32 v130, v130, v4, v1
v_and_or_b32 v131, v131, v4, v1
buffer_store_dwordx4 v[128:131], v213, s[40:43], s68 offen offset:0 sc1
v_and_or_b32 v132, v132, v4, v1
v_and_or_b32 v133, v133, v4, v1
v_and_or_b32 v134, v134, v4, v1
v_and_or_b32 v135, v135, v4, v1
buffer_store_dwordx4 v[132:135], v213, s[40:43], s68 offen offset:128 sc1
v_and_or_b32 v136, v136, v4, v1
v_and_or_b32 v137, v137, v4, v1
v_and_or_b32 v138, v138, v4, v1
v_and_or_b32 v139, v139, v4, v1
buffer_store_dwordx4 v[136:139], v213, s[40:43], s68 offen offset:256 sc1
v_and_or_b32 v140, v140, v4, v1
v_and_or_b32 v141, v141, v4, v1
v_and_or_b32 v142, v142, v4, v1
v_and_or_b32 v143, v143, v4, v1
buffer_store_dwordx4 v[140:143], v213, s[40:43], s68 offen offset:384 sc1
v_and_or_b32 v144, v144, v4, v1
v_and_or_b32 v145, v145, v4, v1
v_and_or_b32 v146, v146, v4, v1
v_and_or_b32 v147, v147, v4, v1
buffer_store_dwordx4 v[144:147], v213, s[40:43], s68 offen offset:512 sc1
v_and_or_b32 v148, v148, v4, v1
v_and_or_b32 v149, v149, v4, v1
v_and_or_b32 v150, v150, v4, v1
v_and_or_b32 v151, v151, v4, v1
buffer_store_dwordx4 v[148:151], v213, s[40:43], s68 offen offset:640 sc1
v_and_or_b32 v152, v152, v4, v1
v_and_or_b32 v153, v153, v4, v1
v_and_or_b32 v154, v154, v4, v1
v_and_or_b32 v155, v155, v4, v1
buffer_store_dwordx4 v[152:155], v213, s[40:43], s68 offen offset:768 sc1
s_nop 1
v_and_or_b32 v156, v156, v4, v1
v_and_or_b32 v157, v157, v4, v1
v_and_or_b32 v158, v158, v4, v1
v_and_or_b32 v159, v159, v4, v1
buffer_store_dwordx4 v[156:159], v213, s[40:43], s68 offen offset:896 sc1
s_mov_b64 exec, -1
s_cmp_lg_u32 s58, 0
s_cbranch_scc1 L_exit
s_cmp_ge_u32 s59, 32
s_cbranch_scc1 L_exit
v_lshrrev_b32 v9, 3, v0
v_lshlrev_b32 v8, 12, v9
v_and_b32 v10, 7, v0
v_lshlrev_b32 v10, 4, v10
v_add_u32 v8, v8, v10
v_cmp_gt_u32 vcc, 3, v9
s_lshl_b32 s54, s59, 7
s_add_u32 s54, s54, 622592
v_cndmask_b32 v11, v10, v8, vcc
v_cndmask_b32 v12, 0, 1.0, vcc
ds_read_b128 v[44:47], v199 offset:16384
v_lshrrev_b32 v48, 1, v199
s_mov_b32 s72, s24
s_mov_b32 s73, s25
s_mov_b32 s74, 2048
s_mov_b32 s75, 0x20000
s_mov_b32 s70, 0
L_p_ps_61:
s_add_u32 s55, s54, 0
buffer_load_dwordx4 v[16:19], v8, s[40:43], s55 offen sc1
s_add_u32 s55, s54, 32768
buffer_load_dwordx4 v[20:23], v8, s[40:43], s55 offen sc1
s_add_u32 s55, s54, 65536
buffer_load_dwordx4 v[24:27], v8, s[40:43], s55 offen sc1
s_add_u32 s55, s54, 98304
buffer_load_dwordx4 v[28:31], v8, s[40:43], s55 offen sc1
s_add_u32 s55, s54, 131072
buffer_load_dwordx4 v[32:35], v8, s[40:43], s55 offen sc1
s_add_u32 s55, s54, 163840
buffer_load_dwordx4 v[36:39], v11, s[40:43], s55 offen sc1
s_waitcnt vmcnt(3)
v_xor_b32 v16, v16, v1
v_xor_b32 v17, v17, v1
v_xor_b32 v18, v18, v1
v_xor_b32 v19, v19, v1
v_xor_b32 v20, v20, v1
v_xor_b32 v21, v21, v1
v_xor_b32 v22, v22, v1
v_xor_b32 v23, v23, v1
v_xor_b32 v24, v24, v1
v_xor_b32 v25, v25, v1
v_xor_b32 v26, v26, v1
v_xor_b32 v27, v27, v1
v_or_b32 v13, v16, v17
v_or3_b32 v13, v13, v18, v19
v_or3_b32 v13, v13, v20, v21
v_or3_b32 v13, v13, v22, v23
v_or3_b32 v13, v13, v24, v25
v_or3_b32 v13, v13, v26, v27
s_waitcnt vmcnt(0)
v_xor_b32 v28, v28, v1
v_xor_b32 v29, v29, v1
v_xor_b32 v30, v30, v1
v_xor_b32 v31, v31, v1
v_xor_b32 v32, v32, v1
v_xor_b32 v33, v33, v1
v_xor_b32 v34, v34, v1
v_xor_b32 v35, v35, v1
v_xor_b32 v36, v36, v1
v_xor_b32 v37, v37, v1
v_xor_b32 v38, v38, v1
v_xor_b32 v39, v39, v1
v_or3_b32 v13, v13, v28, v29
v_or3_b32 v13, v13, v30, v31
v_or3_b32 v13, v13, v32, v33
v_or3_b32 v13, v13, v34, v35
v_or3_b32 v13, v13, v36, v37
v_or3_b32 v13, v13, v38, v39
v_and_b32 v13, 1023, v13
v_cmp_ne_u32 vcc, 0, v13
s_add_u32 s70, s70, 1
s_cmp_gt_u32 s70, 400000
s_cbranch_scc1 L_p_ps_done_62
s_cbranch_vccnz L_p_ps_61
L_p_ps_done_62:
v_pk_add_f32 v[16:17], v[16:17], v[20:21]
v_pk_add_f32 v[24:25], v[24:25], v[28:29]
v_pk_add_f32 v[18:19], v[18:19], v[22:23]
v_pk_add_f32 v[26:27], v[26:27], v[30:31]
v_fma_f32 v32, v36, v12, v32
v_fma_f32 v33, v37, v12, v33
v_fma_f32 v34, v38, v12, v34
v_fma_f32 v35, v39, v12, v35
v_pk_add_f32 v[16:17], v[16:17], v[24:25]
v_pk_add_f32 v[18:19], v[18:19], v[26:27]
v_pk_add_f32 v[16:17], v[16:17], v[32:33]
v_pk_add_f32 v[18:19], v[18:19], v[34:35]
s_nop 0
v_add_f32_dpp v16, v16, v16 row_ror:8 row_mask:0xf bank_mask:0xf
v_add_f32_dpp v17, v17, v17 row_ror:8 row_mask:0xf bank_mask:0xf
v_add_f32_dpp v18, v18, v18 row_ror:8 row_mask:0xf bank_mask:0xf
v_add_f32_dpp v19, v19, v19 row_ror:8 row_mask:0xf bank_mask:0xf
s_nop 0
v_mov_b32 v20, v16
v_mov_b32 v21, v17
v_mov_b32 v22, v18
v_mov_b32 v23, v19
s_nop 1
v_permlane16_swap_b32 v16, v20
v_permlane16_swap_b32 v17, v21
v_permlane16_swap_b32 v18, v22
v_permlane16_swap_b32 v19, v23
s_nop 1
v_add_f32 v16, v16, v20
v_add_f32 v17, v17, v21
v_add_f32 v18, v18, v22
v_add_f32 v19, v19, v23
s_nop 0
v_mov_b32 v20, v16
v_mov_b32 v21, v17
v_mov_b32 v22, v18
v_mov_b32 v23, v19
s_nop 1
v_permlane32_swap_b32 v16, v20
v_permlane32_swap_b32 v17, v21
v_permlane32_swap_b32 v18, v22
v_permlane32_swap_b32 v19, v23
s_nop 1
v_add_f32 v16, v16, v20
v_add_f32 v17, v17, v21
v_add_f32 v18, v18, v22
v_add_f32 v19, v19, v23
s_waitcnt lgkmcnt(0)
v_pk_fma_f32 v[16:17], v[16:17], v[236:237], v[44:45]
v_pk_fma_f32 v[18:19], v[18:19], v[238:239], v[46:47]
v_cvt_pk_bf16_f32 v16, v16, v17
v_cvt_pk_bf16_f32 v17, v18, v19
s_mov_b64 exec, 0xff
buffer_store_dwordx2 v[16:17], v48, s[72:75], 0 offen
s_endpgm
L_exit:
s_endpgm
L_end:
s_endpgm
.section .rodata,"a"
.p2align 6
.amdhsa_kernel adaLN_cond__gqa_block_cached__dense_activation_silu__decode_kernel
  .amdhsa_next_free_vgpr 256
  .amdhsa_next_free_sgpr 102
  .amdhsa_accum_offset 256
  .amdhsa_group_segment_fixed_size 0
  .amdhsa_kernarg_size 104
  .amdhsa_user_sgpr_count 2
  .amdhsa_user_sgpr_kernarg_segment_ptr 1
  .amdhsa_system_sgpr_workgroup_id_x 1
  .amdhsa_float_denorm_mode_32 3
.end_amdhsa_kernel
```
